```python
import torch

def _softmax(x, axis=-1):
    return torch.softmax(x, dim=axis)
def _gelu(x):
    return torch.nn.functional.gelu(x, approximate="tanh")
def _silu(x):
    return torch.nn.functional.silu(x)
def _sigmoid(x):
    return torch.sigmoid(x)
def _layernorm(x, axis=-1, eps=1e-5):
    m = x.mean(dim=axis, keepdim=True)
    v = x.var(dim=axis, keepdim=True, unbiased=False)
    return (x - m) / torch.sqrt(v + eps)
def _scatter_add(tgt, idx, src, axis=0):
    return tgt.clone().index_add_(axis, idx, src)
def _segment_sum(src, seg, n):
    out = torch.zeros((n,) + src.shape[1:], dtype=src.dtype)
    return out.index_add_(0, seg, src)
def _pad(x, pw):
    flat = tuple(v for pair in reversed(pw) for v in pair)
    return torch.nn.functional.pad(x, flat)

kernel_name = 'recurrent_scan__gqa_block_cached__mixer_channel_mlp__decode'

def setup_inputs():

    _w = (lambda a: (lambda t: t.to(torch.bfloat16) if t.is_floating_point() else t)(torch.as_tensor(a)))
    def _A_setup():
        B, Sq, D = 4, 1, 512
        Hq, Hkv, Sk, Dh = 32, 8, 16384, 128
        assert Hq % Hkv == 0, (Hq, Hkv)
        return {
            "x": _w((lambda *s: torch.randn(*s, dtype=torch.bfloat16) * 0.1)(B, Sq, D)),
            "k_cache": _w((lambda *s: torch.randn(*s, dtype=torch.bfloat16) * 0.8)(B, Hkv, Sk, Dh)),
            "v_cache": _w((lambda *s: torch.randn(*s, dtype=torch.bfloat16) * 3.2)(B, Hkv, Sk, Dh)),
            "wq": _w((lambda *s: torch.randn(*s, dtype=torch.bfloat16) * 0.8)(D, Hq * Dh) * (D ** -0.5)),
            "wo": _w((lambda *s: torch.randn(*s, dtype=torch.bfloat16) * 3.2)(Hq * Dh, D) * ((Hq * Dh) ** -0.5)),
        }
    _A_in = _A_setup()

    def _B_setup():
        B, S, D, F = 4, 1, 512, 1792
        return {
            "x": _w((lambda *s: torch.randn(*s, dtype=torch.bfloat16) * 0.1)(B, S, D)),
            "w1": _w((lambda *s: torch.randn(*s, dtype=torch.bfloat16) * 3.2)(D, F) * (D ** -0.5)),
            "b1": _w((lambda *s: torch.randn(*s, dtype=torch.bfloat16) * 3.2)(F)),
            "w2": _w((lambda *s: torch.randn(*s, dtype=torch.bfloat16) * 3.2)(F, D) * (F ** -0.5)),
            "b2": _w((lambda *s: torch.randn(*s, dtype=torch.bfloat16) * 3.2)(D)),
        }
    _B_in = _B_setup()

    return {
        "A_x": _A_in["x"],
        "A_k_cache": _A_in["k_cache"],
        "A_v_cache": _A_in["v_cache"],
        "A_wq": _A_in["wq"],
        "A_wo": _A_in["wo"],
        "B_x": _B_in["x"],
        "B_w1": _B_in["w1"],
        "B_b1": _B_in["b1"],
        "B_w2": _B_in["w2"],
        "B_b2": _B_in["b2"],
    }

def reference(A_x, A_k_cache, A_v_cache, A_wq, A_wo, B_x, B_w1, B_b1, B_w2, B_b2):
    def _A_ref(x, k_cache, v_cache, wq, wo):
        B, Sq, D = x.shape
        Hq, Dh = 32, 128
        Hkv = k_cache.shape[1]
        rep = Hq // Hkv
        q = (lambda x, *d: x.permute(*d))((x @ wq).reshape(B, Sq, Hq, Dh), 0, 2, 1, 3)
        k = (lambda x, n, axis: torch.repeat_interleave(x, n, dim=axis))(k_cache, rep, axis=1)
        v = (lambda x, n, axis: torch.repeat_interleave(x, n, dim=axis))(v_cache, rep, axis=1)
        scores = torch.einsum("bhqd,bhkd->bhqk", q, k) * (Dh ** -0.5)
        p = _softmax(scores, axis=-1)
        o = torch.einsum("bhqk,bhkd->bhqd", p, v)
        return (lambda x, *d: x.permute(*d))(o, 0, 2, 1, 3).reshape(B, Sq, Hq * Dh) @ wo

    def _B_ref(x, w1, b1, w2, b2):
        y = _layernorm(x, axis=-1)
        h = _gelu(torch.einsum("bsd,df->bsf", y, w1) + b1)
        return torch.einsum("bsf,fd->bsd", h, w2) + b2

    x = A_x
    xn = _layernorm(x, axis=-1)
    s = _A_ref(xn, A_k_cache, A_v_cache, A_wq, A_wo)
    g = _silu(_B_ref(xn, B_w1, B_b1, B_w2, B_b2))
    return x + s * g
```

```asm
; @launch grid=(256,1,1) block=(512,1,1) lds=163840
.amdgcn_target "amdgcn-amd-amdhsa--gfx950"
.text
.globl recurrent_scan__gqa_block_cached__mixer_channel_mlp__decode_kernel
.p2align 8
.type recurrent_scan__gqa_block_cached__mixer_channel_mlp__decode_kernel,@function
recurrent_scan__gqa_block_cached__mixer_channel_mlp__decode_kernel:
    s_cmp_ge_u32 s2, 256
    s_cbranch_scc1 L_exit
    s_load_dwordx16 s[16:31], s[0:1], 0
    s_load_dwordx8 s[32:39], s[0:1], 64
    s_load_dwordx2 s[40:41], s[0:1], 96
    v_lshrrev_b32 v4, 6, v0
    v_and_b32 v1, 63, v0
    v_readfirstlane_b32 s3, v4
    v_lshrrev_b32 v2, 4, v1
    v_and_b32 v3, 15, v1
    s_lshr_b32 s4, s2, 3
    s_and_b32 s5, s2, 7
    s_lshr_b32 s6, s4, 3
    s_and_b32 s7, s4, 7
    s_lshl_b32 s10, s3, 14
    v_lshlrev_b32 v27, 4, v1
    v_lshrrev_b32 v6, 3, v1
    v_and_b32 v7, 7, v1
    v_lshlrev_b32 v7, 4, v7
    v_lshl_add_u32 v26, v6, 10, v7
    v_mov_b32 v31, 0
    s_sub_u32 s100, s5, s4
    s_and_b32 s100, s100, 7
    s_cmp_lt_u32 s4, 28
    s_cselect_b32 s98, 2, 0
    s_cmp_eq_u32 s100, 2
    s_cselect_b32 s98, s98, 0
    s_cmp_lt_u32 s100, 2
    s_cselect_b32 s98, 1, s98
    s_cmp_eq_u32 s98, 2
    s_cselect_b32 s42, 1, 0
    s_cselect_b32 s98, 0, s98
    s_lshl_b32 s89, s4, 1
    s_add_u32 s89, s89, s100
    s_mov_b32 s90, 3584
    s_mov_b32 s91, 151552
    s_mov_b32 s58, 1835008
    s_cmp_eq_u32 s98, 1
    s_cselect_b32 s89, s89, s4
    s_cselect_b32 s90, 8192, s90
    s_cselect_b32 s91, 147456, s91
    s_cselect_b32 s58, 4194304, s58
    s_mov_b32 s59, 0x20000
    s_lshl_b32 s92, s89, 7
    v_mul_lo_u32 v6, v6, s90
    v_add_u32 v6, v6, v7
    s_and_b32 s93, s3, 3
    s_lshl_b32 s94, s93, 10
    s_lshl_b32 s9, s3, 6
    s_mul_i32 s9, s9, s90
    s_add_u32 s9, s9, s92
    s_lshl_b32 s11, s90, 3
    v_lshlrev_b32 v7, 1, v1
    s_mov_b32 s12, 3145728
    s_waitcnt lgkmcnt(0)
    s_cmp_eq_u32 s98, 1
    s_cselect_b32 s56, s22, s28
    s_cselect_b32 s57, s23, s29
    s_mov_b32 s60, s16
    s_mov_b32 s61, s17
    s_mov_b32 s62, 4096
    s_mov_b32 s63, 0x20000
    s_mov_b32 s52, s40
    s_mov_b32 s53, s41
    s_mov_b32 s54, 536870912
    s_mov_b32 s55, 0x20000
    s_mov_b32 s76, s30
    s_mov_b32 s77, s31
    s_mov_b32 s78, 3584
    s_mov_b32 s79, 0x20000
    s_mov_b32 s64, s32
    s_mov_b32 s65, s33
    s_mov_b32 s66, 1835008
    s_mov_b32 s67, 0x20000
    buffer_load_dword v170, v31, s[52:55], s12 offen sc1
    s_cmp_eq_u32 s98, 0
    s_cbranch_scc1 L_setup
    buffer_load_dwordx4 v[48:51], v27, s[60:63], s94 offen
    buffer_load_ushort v52, v7, s[76:79], s92 offen
    s_add_u32 m0, s10, 8192
    s_nop 0
    buffer_load_dwordx4 v6, s[56:59], s9 offen nt lds
    s_add_u32 s9, s9, s11
    s_add_u32 m0, s10, 9216
    s_nop 0
    buffer_load_dwordx4 v6, s[56:59], s9 offen nt lds
    s_add_u32 s9, s9, s11
    s_add_u32 m0, s10, 10240
    s_nop 0
    buffer_load_dwordx4 v6, s[56:59], s9 offen nt lds
    s_add_u32 s9, s9, s11
    s_add_u32 m0, s10, 11264
    s_nop 0
    buffer_load_dwordx4 v6, s[56:59], s9 offen nt lds
    s_add_u32 s9, s9, s11
    s_add_u32 m0, s10, 12288
    s_nop 0
    buffer_load_dwordx4 v6, s[56:59], s9 offen nt lds
    s_add_u32 s9, s9, s11
    s_add_u32 m0, s10, 13312
    s_nop 0
    buffer_load_dwordx4 v6, s[56:59], s9 offen nt lds
    s_add_u32 s9, s9, s11
    s_add_u32 m0, s10, 14336
    s_nop 0
    buffer_load_dwordx4 v6, s[56:59], s9 offen nt lds
    s_add_u32 s9, s9, s11
    s_add_u32 m0, s10, 15360
    s_nop 0
    buffer_load_dwordx4 v6, s[56:59], s9 offen nt lds
    s_cmp_eq_u32 s98, 1
    s_cbranch_scc1 L_setup
    s_lshl_b32 s9, s89, 16
    s_lshl_b32 s11, s3, 7
    s_add_u32 s9, s9, s11
    s_add_u32 m0, s10, 0
    s_nop 0
    buffer_load_dwordx4 v26, s[64:67], s9 offen nt lds
    s_add_u32 s9, s9, 8192
    s_add_u32 m0, s10, 1024
    s_nop 0
    buffer_load_dwordx4 v26, s[64:67], s9 offen nt lds
    s_add_u32 s9, s9, 8192
    s_add_u32 m0, s10, 2048
    s_nop 0
    buffer_load_dwordx4 v26, s[64:67], s9 offen nt lds
    s_add_u32 s9, s9, 8192
    s_add_u32 m0, s10, 3072
    s_nop 0
    buffer_load_dwordx4 v26, s[64:67], s9 offen nt lds
    s_add_u32 s9, s9, 8192
    s_add_u32 m0, s10, 4096
    s_nop 0
    buffer_load_dwordx4 v26, s[64:67], s9 offen nt lds
    s_add_u32 s9, s9, 8192
    s_add_u32 m0, s10, 5120
    s_nop 0
    buffer_load_dwordx4 v26, s[64:67], s9 offen nt lds
    s_add_u32 s9, s9, 8192
    s_add_u32 m0, s10, 6144
    s_nop 0
    buffer_load_dwordx4 v26, s[64:67], s9 offen nt lds
    s_add_u32 s9, s9, 8192
    s_add_u32 m0, s10, 7168
    s_nop 0
    buffer_load_dwordx4 v26, s[64:67], s9 offen nt lds
L_setup:
    s_nop 7
    s_mov_b32 s44, s18
    s_mov_b32 s45, s19
    s_mov_b32 s46, 134217728
    s_mov_b32 s47, 0x20000
    s_mov_b32 s48, s20
    s_mov_b32 s49, s21
    s_mov_b32 s50, 134217728
    s_mov_b32 s51, 0x20000
    s_mov_b32 s68, s24
    s_mov_b32 s69, s25
    s_mov_b32 s70, 4194304
    s_mov_b32 s71, 0x20000
    s_mov_b32 s72, s38
    s_mov_b32 s73, s39
    s_mov_b32 s74, 256
    s_mov_b32 s75, 0x20000
    s_mov_b32 s80, s36
    s_mov_b32 s81, s37
    s_mov_b32 s82, 4096
    s_mov_b32 s83, 0x20000
    s_mov_b32 s24, 269356815
    s_mov_b32 s25, 286331153
    s_mov_b32 s26, 740167424
    s_mov_b32 s27, 1868451132
    s_mov_b32 s28, 269487887
    s_mov_b32 s29, 286330896
    s_mov_b32 s30, 773721856
    s_mov_b32 s31, 1868451390
    s_cmp_lt_u32 s4, 28
    s_cselect_b64 s[24:25], s[24:25], s[28:29]
    s_cselect_b64 s[26:27], s[26:27], s[30:31]
    s_lshl_b32 s9, s100, 3
    s_lshr_b64 s[24:25], s[24:25], s9
    s_lshr_b64 s[26:27], s[26:27], s9
    s_and_b32 s99, s24, 0xff
    s_and_b32 s9, s26, 0xff
    s_lshl_b32 s8, s4, 22
    s_lshl_b32 s9, s9, 15
    s_add_u32 s8, s8, s9
    s_lshl_b32 s9, s3, 12
    s_add_u32 s8, s8, s9
    s_mov_b32 s13, 0x3e0293ee
    v_xor_b32 v5, v3, v2
    v_xor_b32 v6, 0, v5
    v_lshlrev_b32 v6, 4, v6
    v_lshl_add_u32 v8, v2, 8, v6
    v_xor_b32 v6, 4, v5
    v_lshlrev_b32 v6, 4, v6
    v_lshl_add_u32 v9, v2, 8, v6
    v_xor_b32 v6, 8, v5
    v_lshlrev_b32 v6, 4, v6
    v_lshl_add_u32 v10, v2, 8, v6
    v_xor_b32 v6, 12, v5
    v_lshlrev_b32 v6, 4, v6
    v_lshl_add_u32 v11, v2, 8, v6
    v_add_u32 v6, 0, v2
    v_lshlrev_b32 v6, 1, v6
    v_xor_b32 v6, v6, v3
    v_lshlrev_b32 v6, 4, v6
    v_lshl_add_u32 v12, v2, 8, v6
    v_add_u32 v6, 4, v2
    v_lshlrev_b32 v6, 1, v6
    v_xor_b32 v6, v6, v3
    v_lshlrev_b32 v6, 4, v6
    v_lshl_add_u32 v13, v2, 8, v6
    v_lshrrev_b32 v6, 7, v0
    v_mul_u32_u24 v6, 9216, v6
    v_and_b32 v7, 127, v0
    v_lshl_add_u32 v28, v7, 3, v6
    v_add_u32 v29, 1024, v6
    v_and_b32 v7, 255, v0
    v_lshlrev_b32 v30, 2, v7
    s_mul_i32 s84, s4, 36864
    s_mul_i32 s9, s5, 1152
    s_add_u32 s84, s84, s9
    s_add_u32 s84, s84, 5242880
    s_lshl_b32 s85, s5, 5
    s_add_u32 s85, s85, s4
    s_lshl_b32 s85, s85, 11
    s_add_u32 s85, s85, 7340032
    v_xor_b32 v6, 0, v5
    v_lshlrev_b32 v6, 4, v6
    v_lshl_add_u32 v6, v3, 8, v6
    v_add_u32 v14, s10, v6
    v_xor_b32 v6, 4, v5
    v_lshlrev_b32 v6, 4, v6
    v_lshl_add_u32 v6, v3, 8, v6
    v_add_u32 v15, s10, v6
    v_xor_b32 v6, 8, v5
    v_lshlrev_b32 v6, 4, v6
    v_lshl_add_u32 v6, v3, 8, v6
    v_add_u32 v16, s10, v6
    v_xor_b32 v6, 12, v5
    v_lshlrev_b32 v6, 4, v6
    v_lshl_add_u32 v6, v3, 8, v6
    v_add_u32 v17, s10, v6
    v_lshrrev_b32 v6, 2, v1
    v_and_b32 v7, 7, v6
    v_lshlrev_b32 v6, 8, v6
    v_and_b32 v32, 3, v1
    v_lshl_add_u32 v6, v32, 3, v6
    v_add_u32 v6, s10, v6
    v_xor_b32 v33, 0, v7
    v_lshl_add_u32 v18, v33, 5, v6
    v_xor_b32 v33, 1, v7
    v_lshl_add_u32 v19, v33, 5, v6
    v_xor_b32 v33, 2, v7
    v_lshl_add_u32 v20, v33, 5, v6
    v_xor_b32 v33, 3, v7
    v_lshl_add_u32 v21, v33, 5, v6
    v_xor_b32 v33, 4, v7
    v_lshl_add_u32 v22, v33, 5, v6
    v_xor_b32 v33, 5, v7
    v_lshl_add_u32 v23, v33, 5, v6
    v_xor_b32 v33, 6, v7
    v_lshl_add_u32 v24, v33, 5, v6
    v_xor_b32 v33, 7, v7
    v_lshl_add_u32 v25, v33, 5, v6
    v_lshlrev_b32 v171, 5, v1
    s_lshl_b32 s88, s6, 14
    s_lshl_b32 s11, s7, 11
    s_add_u32 s88, s88, s11
    s_add_u32 s88, s88, 2097152
    s_cmp_eq_u32 s98, 0
    s_cbranch_scc1 L_pissue
    s_cmp_eq_u32 s98, 1
    s_cbranch_scc1 L_now2
    s_waitcnt vmcnt(17)
    s_branch L_xin
L_now2:
    s_nop 7
    s_waitcnt vmcnt(9)
L_xin:
    s_nop 7
    v_lshlrev_b32 v56, 16, v48
    v_and_b32 v57, 0xffff0000, v48
    v_lshlrev_b32 v58, 16, v49
    v_and_b32 v59, 0xffff0000, v49
    v_lshlrev_b32 v60, 16, v50
    v_and_b32 v61, 0xffff0000, v50
    v_lshlrev_b32 v62, 16, v51
    v_and_b32 v63, 0xffff0000, v51
    v_add_f32 v64, v56, v57
    v_add_f32 v64, v64, v58
    v_add_f32 v64, v64, v59
    v_add_f32 v64, v64, v60
    v_add_f32 v64, v64, v61
    v_add_f32 v64, v64, v62
    v_add_f32 v64, v64, v63
    s_nop 1
    v_add_f32_dpp v64, v64, v64 quad_perm:[1,0,3,2] row_mask:0xf bank_mask:0xf
    s_nop 1
    v_add_f32_dpp v64, v64, v64 quad_perm:[2,3,0,1] row_mask:0xf bank_mask:0xf
    s_nop 1
    v_add_f32_dpp v64, v64, v64 row_half_mirror row_mask:0xf bank_mask:0xf
    s_nop 1
    v_add_f32_dpp v64, v64, v64 row_mirror row_mask:0xf bank_mask:0xf
    v_mov_b32 v65, v64
    s_nop 1
    v_permlane16_swap_b32 v65, v64
    v_add_f32 v64, v65, v64
    v_mov_b32 v65, v64
    s_nop 1
    v_permlane32_swap_b32 v65, v64
    v_add_f32 v64, v65, v64
    v_mul_f32 v64, 0x3b000000, v64
    v_sub_f32 v65, v56, v64
    v_mul_f32 v67, v65, v65
    v_sub_f32 v65, v57, v64
    v_fmac_f32 v67, v65, v65
    v_sub_f32 v65, v58, v64
    v_fmac_f32 v67, v65, v65
    v_sub_f32 v65, v59, v64
    v_fmac_f32 v67, v65, v65
    v_sub_f32 v65, v60, v64
    v_fmac_f32 v67, v65, v65
    v_sub_f32 v65, v61, v64
    v_fmac_f32 v67, v65, v65
    v_sub_f32 v65, v62, v64
    v_fmac_f32 v67, v65, v65
    v_sub_f32 v65, v63, v64
    v_fmac_f32 v67, v65, v65
    s_nop 1
    v_add_f32_dpp v67, v67, v67 quad_perm:[1,0,3,2] row_mask:0xf bank_mask:0xf
    s_nop 1
    v_add_f32_dpp v67, v67, v67 quad_perm:[2,3,0,1] row_mask:0xf bank_mask:0xf
    s_nop 1
    v_add_f32_dpp v67, v67, v67 row_half_mirror row_mask:0xf bank_mask:0xf
    s_nop 1
    v_add_f32_dpp v67, v67, v67 row_mirror row_mask:0xf bank_mask:0xf
    v_mov_b32 v65, v67
    s_nop 1
    v_permlane16_swap_b32 v65, v67
    v_add_f32 v67, v65, v67
    v_mov_b32 v65, v67
    s_nop 1
    v_permlane32_swap_b32 v65, v67
    v_add_f32 v67, v65, v67
    v_mul_f32 v67, 0x3b000000, v67
    v_cvt_pk_bf16_f32 v66, v64, v64
    v_lshlrev_b32 v66, 16, v66
    v_cvt_pk_bf16_f32 v67, v67, v67
    v_lshlrev_b32 v67, 16, v67
    v_add_f32 v67, 0x3727c5ac, v67
    v_cvt_pk_bf16_f32 v67, v67, v67
    v_lshlrev_b32 v67, 16, v67
    v_sqrt_f32 v67, v67
    s_nop 0
    v_cvt_pk_bf16_f32 v67, v67, v67
    v_lshlrev_b32 v67, 16, v67
    v_rcp_f32 v67, v67
    v_sub_f32 v56, v56, v66
    v_sub_f32 v57, v57, v66
    v_cvt_pk_bf16_f32 v65, v56, v57
    v_lshlrev_b32 v56, 16, v65
    v_and_b32 v57, 0xffff0000, v65
    v_mul_f32 v56, v56, v67
    v_mul_f32 v57, v57, v67
    v_cvt_pk_bf16_f32 v72, v56, v57
    v_lshlrev_b32 v56, 16, v72
    v_and_b32 v57, 0xffff0000, v72
    v_sub_f32 v58, v58, v66
    v_sub_f32 v59, v59, v66
    v_cvt_pk_bf16_f32 v65, v58, v59
    v_lshlrev_b32 v58, 16, v65
    v_and_b32 v59, 0xffff0000, v65
    v_mul_f32 v58, v58, v67
    v_mul_f32 v59, v59, v67
    v_cvt_pk_bf16_f32 v73, v58, v59
    v_lshlrev_b32 v58, 16, v73
    v_and_b32 v59, 0xffff0000, v73
    v_sub_f32 v60, v60, v66
    v_sub_f32 v61, v61, v66
    v_cvt_pk_bf16_f32 v65, v60, v61
    v_lshlrev_b32 v60, 16, v65
    v_and_b32 v61, 0xffff0000, v65
    v_mul_f32 v60, v60, v67
    v_mul_f32 v61, v61, v67
    v_cvt_pk_bf16_f32 v74, v60, v61
    v_lshlrev_b32 v60, 16, v74
    v_and_b32 v61, 0xffff0000, v74
    v_sub_f32 v62, v62, v66
    v_sub_f32 v63, v63, v66
    v_cvt_pk_bf16_f32 v65, v62, v63
    v_lshlrev_b32 v62, 16, v65
    v_and_b32 v63, 0xffff0000, v65
    v_mul_f32 v62, v62, v67
    v_mul_f32 v63, v63, v67
    v_cvt_pk_bf16_f32 v75, v62, v63
    v_lshlrev_b32 v62, 16, v75
    v_and_b32 v63, 0xffff0000, v75
    v_add_u32 v6, s94, v27
    v_add_u32 v6, 147456, v6
    v_and_b32 v7, 3, v1
    v_lshlrev_b32 v53, 10, v7
    v_lshl_add_u32 v53, v2, 3, v53
    s_lshl_b32 s9, s3, 7
    s_add_u32 s9, s9, s91
    v_add_u32 v53, s9, v53
    v_lshrrev_b32 v54, 2, v1
    v_lshlrev_b32 v54, 7, v54
    v_lshl_add_u32 v54, v7, 3, v54
    v_add_u32 v54, s10, v54
    v_lshlrev_b32 v55, 8, v3
    v_lshl_add_u32 v55, v2, 4, v55
    s_lshl_b32 s9, s3, 10
    s_add_u32 s9, s9, 155648
    v_add_u32 v55, s9, v55
    s_cmp_eq_u32 s98, 1
    s_cbranch_scc1 L_lnq
    v_add_f32 v64, v56, v57
    v_add_f32 v64, v64, v58
    v_add_f32 v64, v64, v59
    v_add_f32 v64, v64, v60
    v_add_f32 v64, v64, v61
    v_add_f32 v64, v64, v62
    v_add_f32 v64, v64, v63
    s_nop 1
    v_add_f32_dpp v64, v64, v64 quad_perm:[1,0,3,2] row_mask:0xf bank_mask:0xf
    s_nop 1
    v_add_f32_dpp v64, v64, v64 quad_perm:[2,3,0,1] row_mask:0xf bank_mask:0xf
    s_nop 1
    v_add_f32_dpp v64, v64, v64 row_half_mirror row_mask:0xf bank_mask:0xf
    s_nop 1
    v_add_f32_dpp v64, v64, v64 row_mirror row_mask:0xf bank_mask:0xf
    v_mov_b32 v65, v64
    s_nop 1
    v_permlane16_swap_b32 v65, v64
    v_add_f32 v64, v65, v64
    v_mov_b32 v65, v64
    s_nop 1
    v_permlane32_swap_b32 v65, v64
    v_add_f32 v64, v65, v64
    v_mul_f32 v64, 0x3b000000, v64
    v_sub_f32 v65, v56, v64
    v_mul_f32 v67, v65, v65
    v_sub_f32 v65, v57, v64
    v_fmac_f32 v67, v65, v65
    v_sub_f32 v65, v58, v64
    v_fmac_f32 v67, v65, v65
    v_sub_f32 v65, v59, v64
    v_fmac_f32 v67, v65, v65
    v_sub_f32 v65, v60, v64
    v_fmac_f32 v67, v65, v65
    v_sub_f32 v65, v61, v64
    v_fmac_f32 v67, v65, v65
    v_sub_f32 v65, v62, v64
    v_fmac_f32 v67, v65, v65
    v_sub_f32 v65, v63, v64
    v_fmac_f32 v67, v65, v65
    s_nop 1
    v_add_f32_dpp v67, v67, v67 quad_perm:[1,0,3,2] row_mask:0xf bank_mask:0xf
    s_nop 1
    v_add_f32_dpp v67, v67, v67 quad_perm:[2,3,0,1] row_mask:0xf bank_mask:0xf
    s_nop 1
    v_add_f32_dpp v67, v67, v67 row_half_mirror row_mask:0xf bank_mask:0xf
    s_nop 1
    v_add_f32_dpp v67, v67, v67 row_mirror row_mask:0xf bank_mask:0xf
    v_mov_b32 v65, v67
    s_nop 1
    v_permlane16_swap_b32 v65, v67
    v_add_f32 v67, v65, v67
    v_mov_b32 v65, v67
    s_nop 1
    v_permlane32_swap_b32 v65, v67
    v_add_f32 v67, v65, v67
    v_mul_f32 v67, 0x3b000000, v67
    v_cvt_pk_bf16_f32 v66, v64, v64
    v_lshlrev_b32 v66, 16, v66
    v_cvt_pk_bf16_f32 v67, v67, v67
    v_lshlrev_b32 v67, 16, v67
    v_add_f32 v67, 0x3727c5ac, v67
    v_cvt_pk_bf16_f32 v67, v67, v67
    v_lshlrev_b32 v67, 16, v67
    v_sqrt_f32 v67, v67
    s_nop 0
    v_cvt_pk_bf16_f32 v67, v67, v67
    v_lshlrev_b32 v67, 16, v67
    v_rcp_f32 v67, v67
    v_sub_f32 v56, v56, v66
    v_sub_f32 v57, v57, v66
    v_cvt_pk_bf16_f32 v65, v56, v57
    v_lshlrev_b32 v56, 16, v65
    v_and_b32 v57, 0xffff0000, v65
    v_mul_f32 v56, v56, v67
    v_mul_f32 v57, v57, v67
    v_cvt_pk_bf16_f32 v72, v56, v57
    v_lshlrev_b32 v56, 16, v72
    v_and_b32 v57, 0xffff0000, v72
    v_sub_f32 v58, v58, v66
    v_sub_f32 v59, v59, v66
    v_cvt_pk_bf16_f32 v65, v58, v59
    v_lshlrev_b32 v58, 16, v65
    v_and_b32 v59, 0xffff0000, v65
    v_mul_f32 v58, v58, v67
    v_mul_f32 v59, v59, v67
    v_cvt_pk_bf16_f32 v73, v58, v59
    v_lshlrev_b32 v58, 16, v73
    v_and_b32 v59, 0xffff0000, v73
    v_sub_f32 v60, v60, v66
    v_sub_f32 v61, v61, v66
    v_cvt_pk_bf16_f32 v65, v60, v61
    v_lshlrev_b32 v60, 16, v65
    v_and_b32 v61, 0xffff0000, v65
    v_mul_f32 v60, v60, v67
    v_mul_f32 v61, v61, v67
    v_cvt_pk_bf16_f32 v74, v60, v61
    v_lshlrev_b32 v60, 16, v74
    v_and_b32 v61, 0xffff0000, v74
    v_sub_f32 v62, v62, v66
    v_sub_f32 v63, v63, v66
    v_cvt_pk_bf16_f32 v65, v62, v63
    v_lshlrev_b32 v62, 16, v65
    v_and_b32 v63, 0xffff0000, v65
    v_mul_f32 v62, v62, v67
    v_mul_f32 v63, v63, v67
    v_cvt_pk_bf16_f32 v75, v62, v63
    v_lshlrev_b32 v62, 16, v75
    v_and_b32 v63, 0xffff0000, v75
    ds_write_b128 v6, v[72:75] offset:4096
    s_waitcnt vmcnt(8) lgkmcnt(0)
    s_branch L_p1
L_lnq:
    s_nop 7
    ds_write_b128 v6, v[72:75]
    s_waitcnt vmcnt(0) lgkmcnt(0)
L_p1:
    s_nop 7
    s_barrier
    ds_read_b64 v[56:57], v53 offset:0
    ds_read_b64 v[58:59], v53 offset:32
    ds_read_b64 v[60:61], v53 offset:64
    ds_read_b64 v[62:63], v53 offset:96
    ds_read_b64_tr_b16 v[64:65], v54 offset:8192
    ds_read_b64_tr_b16 v[66:67], v54 offset:8224
    ds_read_b64_tr_b16 v[68:69], v54 offset:8256
    ds_read_b64_tr_b16 v[70:71], v54 offset:8288
    ds_read_b64_tr_b16 v[72:73], v54 offset:10240
    ds_read_b64_tr_b16 v[74:75], v54 offset:10272
    ds_read_b64_tr_b16 v[76:77], v54 offset:10304
    ds_read_b64_tr_b16 v[78:79], v54 offset:10336
    ds_read_b64_tr_b16 v[80:81], v54 offset:12288
    ds_read_b64_tr_b16 v[82:83], v54 offset:12320
    ds_read_b64_tr_b16 v[84:85], v54 offset:12352
    ds_read_b64_tr_b16 v[86:87], v54 offset:12384
    ds_read_b64_tr_b16 v[88:89], v54 offset:14336
    ds_read_b64_tr_b16 v[90:91], v54 offset:14368
    ds_read_b64_tr_b16 v[92:93], v54 offset:14400
    ds_read_b64_tr_b16 v[94:95], v54 offset:14432
    s_waitcnt lgkmcnt(0)
    v_mfma_f32_16x16x16_bf16 v[96:99], v[64:65], v[56:57], 0
    v_mfma_f32_16x16x16_bf16 v[100:103], v[66:67], v[56:57], 0
    v_mfma_f32_16x16x16_bf16 v[104:107], v[68:69], v[56:57], 0
    v_mfma_f32_16x16x16_bf16 v[108:111], v[70:71], v[56:57], 0
    v_mfma_f32_16x16x16_bf16 v[96:99], v[72:73], v[58:59], v[96:99]
    v_mfma_f32_16x16x16_bf16 v[100:103], v[74:75], v[58:59], v[100:103]
    v_mfma_f32_16x16x16_bf16 v[104:107], v[76:77], v[58:59], v[104:107]
    v_mfma_f32_16x16x16_bf16 v[108:111], v[78:79], v[58:59], v[108:111]
    v_mfma_f32_16x16x16_bf16 v[96:99], v[80:81], v[60:61], v[96:99]
    v_mfma_f32_16x16x16_bf16 v[100:103], v[82:83], v[60:61], v[100:103]
    v_mfma_f32_16x16x16_bf16 v[104:107], v[84:85], v[60:61], v[104:107]
    v_mfma_f32_16x16x16_bf16 v[108:111], v[86:87], v[60:61], v[108:111]
    v_mfma_f32_16x16x16_bf16 v[96:99], v[88:89], v[62:63], v[96:99]
    v_mfma_f32_16x16x16_bf16 v[100:103], v[90:91], v[62:63], v[100:103]
    v_mfma_f32_16x16x16_bf16 v[104:107], v[92:93], v[62:63], v[104:107]
    v_mfma_f32_16x16x16_bf16 v[108:111], v[94:95], v[62:63], v[108:111]
    v_cmp_gt_u32 vcc, 4, v3
    s_nop 0
    s_and_saveexec_b64 s[86:87], vcc
    s_nop 1
    ds_write_b128 v55, v[96:99] offset:0
    ds_write_b128 v55, v[100:103] offset:64
    ds_write_b128 v55, v[104:107] offset:128
    ds_write_b128 v55, v[108:111] offset:192
    s_mov_b64 exec, s[86:87]
    s_waitcnt lgkmcnt(0)
    s_barrier
    s_cmp_eq_u32 s98, 1
    s_cbranch_scc0 L_mlp2
    s_cmp_ge_u32 s3, 2
    s_cbranch_scc1 L_q_bar
    v_lshlrev_b32 v6, 3, v1
    s_lshl_b32 s9, s3, 9
    s_add_u32 s9, s9, 155648
    v_add_u32 v6, s9, v6
    ds_read_b64 v[56:57], v6 offset:0
    ds_read_b64 v[58:59], v6 offset:1024
    ds_read_b64 v[60:61], v6 offset:2048
    ds_read_b64 v[62:63], v6 offset:3072
    ds_read_b64 v[64:65], v6 offset:4096
    ds_read_b64 v[66:67], v6 offset:5120
    ds_read_b64 v[68:69], v6 offset:6144
    ds_read_b64 v[70:71], v6 offset:7168
    v_and_b32 v7, 31, v1
    v_lshlrev_b32 v7, 3, v7
    v_lshrrev_b32 v53, 5, v1
    v_lshl_add_u32 v7, v53, 14, v7
    s_lshl_b32 s9, s89, 8
    s_lshl_b32 s11, s3, 15
    s_add_u32 s9, s9, s11
    s_add_u32 s9, s9, 2097152
    s_waitcnt lgkmcnt(0)
    v_add_f32 v56, v56, v58
    v_add_f32 v57, v57, v59
    v_add_f32 v56, v56, v60
    v_add_f32 v57, v57, v61
    v_add_f32 v56, v56, v62
    v_add_f32 v57, v57, v63
    v_add_f32 v56, v56, v64
    v_add_f32 v57, v57, v65
    v_add_f32 v56, v56, v66
    v_add_f32 v57, v57, v67
    v_add_f32 v56, v56, v68
    v_add_f32 v57, v57, v69
    v_add_f32 v56, v56, v70
    v_add_f32 v57, v57, v71
    v_cvt_pk_bf16_f32 v56, v56, v57
    v_add_u32 v57, 1, v170
    buffer_store_dwordx2 v[56:57], v7, s[52:55], s9 offen sc1
L_q_bar:
    s_nop 7
    s_barrier
    s_branch L_pissue
L_mlp2:
    s_nop 7
    v_lshlrev_b32 v6, 2, v1
    s_lshl_b32 s9, s93, 8
    s_add_u32 s9, s9, 155648
    v_add_u32 v6, s9, v6
    ds_read_b32 v56, v6 offset:0
    ds_read_b32 v57, v6 offset:1024
    ds_read_b32 v58, v6 offset:2048
    ds_read_b32 v59, v6 offset:3072
    ds_read_b32 v60, v6 offset:4096
    ds_read_b32 v61, v6 offset:5120
    ds_read_b32 v62, v6 offset:6144
    ds_read_b32 v63, v6 offset:7168
    s_waitcnt lgkmcnt(0)
    v_add_f32 v56, v56, v57
    v_add_f32 v56, v56, v58
    v_add_f32 v56, v56, v59
    v_add_f32 v56, v56, v60
    v_add_f32 v56, v56, v61
    v_add_f32 v56, v56, v62
    v_add_f32 v56, v56, v63
    v_cvt_pk_bf16_f32 v56, v56, v56
    v_lshlrev_b32 v56, 16, v56
    v_lshlrev_b32 v52, 16, v52
    v_add_f32 v56, v56, v52
    v_cvt_pk_bf16_f32 v56, v56, v56
    v_lshlrev_b32 v56, 16, v56
    v_mul_f32 v57, v56, v56
    v_mul_f32 v57, 0x3d372713, v57
    v_fma_f32 v57, v57, v56, v56
    v_mul_f32 v57, 0xc0135761, v57
    v_exp_f32 v57, v57
    s_nop 0
    v_add_f32 v57, 1.0, v57
    v_rcp_f32 v57, v57
    s_nop 0
    v_mul_f32 v56, v56, v57
    v_cvt_pk_bf16_f32 v57, v56, v56
    v_lshlrev_b32 v6, 1, v1
    s_lshl_b32 s9, s93, 7
    s_add_u32 s9, s9, 149504
    v_add_u32 v6, s9, v6
    ds_write_b16 v6, v57
    s_waitcnt lgkmcnt(0)
    s_barrier
    v_and_b32 v7, 3, v1
    v_lshlrev_b32 v53, 7, v7
    v_lshl_add_u32 v53, v2, 3, v53
    v_add_u32 v53, 149504, v53
    s_waitcnt vmcnt(0)
    ds_read_b64 v[56:57], v53 offset:0
    ds_read_b64 v[58:59], v53 offset:32
    ds_read_b64 v[60:61], v53 offset:64
    ds_read_b64 v[62:63], v53 offset:96
    ds_read_b64_tr_b16 v[64:65], v54 offset:0
    ds_read_b64_tr_b16 v[66:67], v54 offset:32
    ds_read_b64_tr_b16 v[68:69], v54 offset:64
    ds_read_b64_tr_b16 v[70:71], v54 offset:96
    ds_read_b64_tr_b16 v[72:73], v54 offset:2048
    ds_read_b64_tr_b16 v[74:75], v54 offset:2080
    ds_read_b64_tr_b16 v[76:77], v54 offset:2112
    ds_read_b64_tr_b16 v[78:79], v54 offset:2144
    ds_read_b64_tr_b16 v[80:81], v54 offset:4096
    ds_read_b64_tr_b16 v[82:83], v54 offset:4128
    ds_read_b64_tr_b16 v[84:85], v54 offset:4160
    ds_read_b64_tr_b16 v[86:87], v54 offset:4192
    ds_read_b64_tr_b16 v[88:89], v54 offset:6144
    ds_read_b64_tr_b16 v[90:91], v54 offset:6176
    ds_read_b64_tr_b16 v[92:93], v54 offset:6208
    ds_read_b64_tr_b16 v[94:95], v54 offset:6240
    s_waitcnt lgkmcnt(0)
    v_mfma_f32_16x16x16_bf16 v[96:99], v[64:65], v[56:57], 0
    v_mfma_f32_16x16x16_bf16 v[100:103], v[66:67], v[56:57], 0
    v_mfma_f32_16x16x16_bf16 v[104:107], v[68:69], v[56:57], 0
    v_mfma_f32_16x16x16_bf16 v[108:111], v[70:71], v[56:57], 0
    v_mfma_f32_16x16x16_bf16 v[96:99], v[72:73], v[58:59], v[96:99]
    v_mfma_f32_16x16x16_bf16 v[100:103], v[74:75], v[58:59], v[100:103]
    v_mfma_f32_16x16x16_bf16 v[104:107], v[76:77], v[58:59], v[104:107]
    v_mfma_f32_16x16x16_bf16 v[108:111], v[78:79], v[58:59], v[108:111]
    v_mfma_f32_16x16x16_bf16 v[96:99], v[80:81], v[60:61], v[96:99]
    v_mfma_f32_16x16x16_bf16 v[100:103], v[82:83], v[60:61], v[100:103]
    v_mfma_f32_16x16x16_bf16 v[104:107], v[84:85], v[60:61], v[104:107]
    v_mfma_f32_16x16x16_bf16 v[108:111], v[86:87], v[60:61], v[108:111]
    v_mfma_f32_16x16x16_bf16 v[96:99], v[88:89], v[62:63], v[96:99]
    v_mfma_f32_16x16x16_bf16 v[100:103], v[90:91], v[62:63], v[100:103]
    v_mfma_f32_16x16x16_bf16 v[104:107], v[92:93], v[62:63], v[104:107]
    v_mfma_f32_16x16x16_bf16 v[108:111], v[94:95], v[62:63], v[108:111]
    v_lshlrev_b32 v6, 12, v3
    v_lshl_add_u32 v6, v2, 5, v6
    s_lshl_b32 s9, s89, 14
    s_lshl_b32 s11, s3, 9
    s_add_u32 s9, s9, s11
    s_add_u32 s9, s9, 8388608
    v_add_u32 v7, 1, v170
    v_mov_b32 v56, v96
    v_mov_b32 v57, v7
    v_mov_b32 v58, v97
    v_mov_b32 v59, v7
    v_mov_b32 v60, v98
    v_mov_b32 v61, v7
    v_mov_b32 v62, v99
    v_mov_b32 v63, v7
    v_mov_b32 v64, v100
    v_mov_b32 v65, v7
    v_mov_b32 v66, v101
    v_mov_b32 v67, v7
    v_mov_b32 v68, v102
    v_mov_b32 v69, v7
    v_mov_b32 v70, v103
    v_mov_b32 v71, v7
    v_mov_b32 v72, v104
    v_mov_b32 v73, v7
    v_mov_b32 v74, v105
    v_mov_b32 v75, v7
    v_mov_b32 v76, v106
    v_mov_b32 v77, v7
    v_mov_b32 v78, v107
    v_mov_b32 v79, v7
    v_mov_b32 v80, v108
    v_mov_b32 v81, v7
    v_mov_b32 v82, v109
    v_mov_b32 v83, v7
    v_mov_b32 v84, v110
    v_mov_b32 v85, v7
    v_mov_b32 v86, v111
    v_mov_b32 v87, v7
    v_cmp_gt_u32 vcc, 4, v3
    s_nop 0
    s_and_saveexec_b64 s[86:87], vcc
    buffer_store_dwordx4 v[56:59], v6, s[52:55], s9 offen offset:0 sc1
    buffer_store_dwordx4 v[60:63], v6, s[52:55], s9 offen offset:16 sc1
    buffer_store_dwordx4 v[64:67], v6, s[52:55], s9 offen offset:128 sc1
    buffer_store_dwordx4 v[68:71], v6, s[52:55], s9 offen offset:144 sc1
    buffer_store_dwordx4 v[72:75], v6, s[52:55], s9 offen offset:256 sc1
    buffer_store_dwordx4 v[76:79], v6, s[52:55], s9 offen offset:272 sc1
    buffer_store_dwordx4 v[80:83], v6, s[52:55], s9 offen offset:384 sc1
    buffer_store_dwordx4 v[84:87], v6, s[52:55], s9 offen offset:400 sc1
    s_mov_b64 exec, s[86:87]
L_pissue:
    s_nop 7
    s_add_u32 m0, s10, 0
    s_nop 0
    buffer_load_dwordx4 v8, s[44:47], s8 offen offset:0 nt lds
    buffer_load_dwordx4 v9, s[44:47], s8 offen offset:1024 nt lds
    buffer_load_dwordx4 v10, s[44:47], s8 offen offset:2048 nt lds
    buffer_load_dwordx4 v11, s[44:47], s8 offen offset:3072 nt lds
    s_add_u32 m0, s10, 4096
    s_nop 0
    buffer_load_dwordx4 v12, s[48:51], s8 offen offset:0 nt lds
    buffer_load_dwordx4 v13, s[48:51], s8 offen offset:1024 nt lds
    buffer_load_dwordx4 v12, s[48:51], s8 offen offset:2048 nt lds
    buffer_load_dwordx4 v13, s[48:51], s8 offen offset:3072 nt lds
    s_add_u32 s8, s8, 32768
    s_add_u32 m0, s10, 8192
    s_nop 0
    buffer_load_dwordx4 v8, s[44:47], s8 offen offset:0 nt lds
    buffer_load_dwordx4 v9, s[44:47], s8 offen offset:1024 nt lds
    buffer_load_dwordx4 v10, s[44:47], s8 offen offset:2048 nt lds
    buffer_load_dwordx4 v11, s[44:47], s8 offen offset:3072 nt lds
    s_add_u32 m0, s10, 12288
    s_nop 0
    buffer_load_dwordx4 v12, s[48:51], s8 offen offset:0 nt lds
    buffer_load_dwordx4 v13, s[48:51], s8 offen offset:1024 nt lds
    buffer_load_dwordx4 v12, s[48:51], s8 offen offset:2048 nt lds
    buffer_load_dwordx4 v13, s[48:51], s8 offen offset:3072 nt lds
    s_add_u32 s8, s8, 32768
    s_lshl_b32 s9, s4, 7
    s_lshl_b32 s11, s3, 4
    s_add_u32 s9, s9, s11
    s_lshl_b32 s9, s9, 10
    s_lshl_b32 s11, s5, 7
    s_add_u32 s9, s9, s11
    s_lshl_b32 s11, s3, 11
    s_add_u32 m0, s11, 131072
    s_nop 0
    buffer_load_dwordx4 v26, s[68:71], s9 offen nt lds
    s_add_u32 s9, s9, 8192
    s_add_u32 m0, s11, 132096
    s_nop 0
    buffer_load_dwordx4 v26, s[68:71], s9 offen nt lds
    v_mov_b32 v48, 0
    v_mov_b32 v49, 0
    v_mov_b32 v50, 0
    v_mov_b32 v51, 0
    v_mov_b32 v52, 0
    v_mov_b32 v53, 0
    v_mov_b32 v54, 0
    v_mov_b32 v55, 0
    v_mov_b32 v56, 0
    v_mov_b32 v57, 0
    v_mov_b32 v58, 0
    v_mov_b32 v59, 0
    v_mov_b32 v60, 0
    v_mov_b32 v61, 0
    v_mov_b32 v62, 0
    v_mov_b32 v63, 0
    v_mov_b32 v64, 0
    v_mov_b32 v65, 0
    v_mov_b32 v66, 0
    v_mov_b32 v67, 0
    v_mov_b32 v68, 0
    v_mov_b32 v69, 0
    v_mov_b32 v70, 0
    v_mov_b32 v71, 0
    v_mov_b32 v72, 0
    v_mov_b32 v73, 0
    v_mov_b32 v74, 0
    v_mov_b32 v75, 0
    v_mov_b32 v76, 0
    v_mov_b32 v77, 0
    v_mov_b32 v78, 0
    v_mov_b32 v79, 0
    v_mov_b32 v116, 0xff61b1e6
    v_mov_b32 v117, 0
    s_waitcnt vmcnt(10)
    ds_read_b128 v[128:131], v14 offset:0
    ds_read_b128 v[132:135], v15 offset:0
    ds_read_b128 v[136:139], v16 offset:0
    ds_read_b128 v[140:143], v17 offset:0
    ds_read_b64_tr_b16 v[144:145], v18 offset:4096
    ds_read_b64_tr_b16 v[146:147], v19 offset:4096
    ds_read_b64_tr_b16 v[148:149], v20 offset:4096
    ds_read_b64_tr_b16 v[150:151], v21 offset:4096
    ds_read_b64_tr_b16 v[152:153], v22 offset:4096
    ds_read_b64_tr_b16 v[154:155], v23 offset:4096
    ds_read_b64_tr_b16 v[156:157], v24 offset:4096
    ds_read_b64_tr_b16 v[158:159], v25 offset:4096
    s_waitcnt lgkmcnt(0)
    s_add_u32 m0, s10, 0
    s_nop 0
    buffer_load_dwordx4 v8, s[44:47], s8 offen offset:0 nt lds
    buffer_load_dwordx4 v9, s[44:47], s8 offen offset:1024 nt lds
    buffer_load_dwordx4 v10, s[44:47], s8 offen offset:2048 nt lds
    buffer_load_dwordx4 v11, s[44:47], s8 offen offset:3072 nt lds
    s_add_u32 m0, s10, 4096
    s_nop 0
    buffer_load_dwordx4 v12, s[48:51], s8 offen offset:0 nt lds
    buffer_load_dwordx4 v13, s[48:51], s8 offen offset:1024 nt lds
    buffer_load_dwordx4 v12, s[48:51], s8 offen offset:2048 nt lds
    buffer_load_dwordx4 v13, s[48:51], s8 offen offset:3072 nt lds
    s_add_u32 s8, s8, 32768
    buffer_load_dwordx4 v[160:163], v171, s[52:55], s88 offen sc1
    buffer_load_dwordx4 v[164:167], v171, s[52:55], s88 offen offset:16 sc1
    s_waitcnt vmcnt(0)
    s_cmp_lg_u32 s3, 0
    s_cbranch_scc1 L_qbar
    s_mov_b32 s14, 0
    v_add_u32 v168, 1, v170
    v_xor_b32 v169, v161, v168
    v_xor_b32 v6, v163, v168
    v_or_b32 v169, v169, v6
    v_xor_b32 v6, v165, v168
    v_or_b32 v169, v169, v6
    v_xor_b32 v6, v167, v168
    v_or_b32 v169, v169, v6
    v_cmp_eq_u32 vcc, 0, v169
    s_nop 0
    s_cmp_eq_u64 vcc, exec
    s_cbranch_scc1 L_qgot
L_qpoll:
    s_nop 7
    s_sleep 2
    buffer_load_dwordx4 v[160:163], v171, s[52:55], s88 offen sc1
    buffer_load_dwordx4 v[164:167], v171, s[52:55], s88 offen offset:16 sc1
    s_waitcnt vmcnt(0)
    v_add_u32 v168, 1, v170
    v_xor_b32 v169, v161, v168
    v_xor_b32 v6, v163, v168
    v_or_b32 v169, v169, v6
    v_xor_b32 v6, v165, v168
    v_or_b32 v169, v169, v6
    v_xor_b32 v6, v167, v168
    v_or_b32 v169, v169, v6
    v_cmp_eq_u32 vcc, 0, v169
    s_nop 0
    s_cmp_eq_u64 vcc, exec
    s_cbranch_scc1 L_qgot
    s_add_u32 s14, s14, 1
    s_cmp_lt_u32 s14, 1048576
    s_cbranch_scc1 L_qpoll
L_qgot:
    s_nop 7
    v_mov_b32 v161, v162
    v_mov_b32 v162, v164
    v_mov_b32 v163, v166
    v_add_u32 v6, 147456, v27
    ds_write_b128 v6, v[160:163]
    s_waitcnt lgkmcnt(0)
L_qbar:
    s_nop 7
    v_lshlrev_b32 v6, 2, v1
    v_add_u32 v6, 148992, v6
    s_mov_b64 exec, 0xff
    ds_write_b32 v6, v31
    s_mov_b64 exec, -1
    s_waitcnt lgkmcnt(0)
    v_and_b32 v6, 3, v1
    v_lshlrev_b32 v6, 8, v6
    v_lshl_add_u32 v6, v2, 4, v6
    v_add_u32 v6, 147456, v6
    s_barrier
    ds_read_b128 v[32:35], v6 offset:0
    ds_read_b128 v[36:39], v6 offset:64
    ds_read_b128 v[40:43], v6 offset:128
    ds_read_b128 v[44:47], v6 offset:192
    s_sub_u32 s14, s99, 3
    s_mov_b32 s12, 0
    s_mov_b32 s101, 1
    s_branch L_u1
L_loop:
    s_nop 7
    s_cmp_eq_u32 s12, 0
    s_cbranch_scc1 L_w8_0
    s_waitcnt vmcnt(0)
L_w8_0:
    s_nop 7
    s_waitcnt vmcnt(8)
    ds_read_b128 v[80:83], v14 offset:0
    ds_read_b128 v[84:87], v15 offset:0
    ds_read_b128 v[88:91], v16 offset:0
    ds_read_b128 v[92:95], v17 offset:0
    ds_read_b64_tr_b16 v[96:97], v18 offset:4096
    ds_read_b64_tr_b16 v[98:99], v19 offset:4096
    ds_read_b64_tr_b16 v[100:101], v20 offset:4096
    ds_read_b64_tr_b16 v[102:103], v21 offset:4096
    ds_read_b64_tr_b16 v[104:105], v22 offset:4096
    ds_read_b64_tr_b16 v[106:107], v23 offset:4096
    ds_read_b64_tr_b16 v[108:109], v24 offset:4096
    ds_read_b64_tr_b16 v[110:111], v25 offset:4096
    s_waitcnt lgkmcnt(8)
    v_mfma_f32_16x16x32_bf16 v[112:115], v[80:83], v[32:35], 0
    v_mfma_f32_16x16x32_bf16 v[112:115], v[84:87], v[36:39], v[112:115]
    v_mfma_f32_16x16x32_bf16 v[112:115], v[88:91], v[40:43], v[112:115]
    v_mfma_f32_16x16x32_bf16 v[112:115], v[92:95], v[44:47], v[112:115]
    s_waitcnt lgkmcnt(0)
    s_mov_b32 s15, s12
    s_cmp_eq_u32 s14, 0
    s_cselect_b32 s12, 1, 0
    s_cbranch_scc1 L_noiss_0
    s_sub_u32 s14, s14, 1
    s_add_u32 m0, s10, 0
    s_nop 0
    buffer_load_dwordx4 v8, s[44:47], s8 offen offset:0 nt lds
    buffer_load_dwordx4 v9, s[44:47], s8 offen offset:1024 nt lds
    buffer_load_dwordx4 v10, s[44:47], s8 offen offset:2048 nt lds
    buffer_load_dwordx4 v11, s[44:47], s8 offen offset:3072 nt lds
    s_add_u32 m0, s10, 4096
    s_nop 0
    buffer_load_dwordx4 v12, s[48:51], s8 offen offset:0 nt lds
    buffer_load_dwordx4 v13, s[48:51], s8 offen offset:1024 nt lds
    buffer_load_dwordx4 v12, s[48:51], s8 offen offset:2048 nt lds
    buffer_load_dwordx4 v13, s[48:51], s8 offen offset:3072 nt lds
    s_add_u32 s8, s8, 32768
L_noiss_0:
    s_nop 7
    v_max3_f32 v118, v112, v113, v114
    v_max_f32 v118, v118, v115
    v_mov_b32 v119, v118
    s_nop 1
    v_permlane16_swap_b32 v119, v118
    v_max_f32 v118, v119, v118
    v_mov_b32 v119, v118
    s_nop 1
    v_permlane32_swap_b32 v119, v118
    v_max_f32 v118, v119, v118
    v_max_f32 v118, v118, v116
    v_sub_f32 v120, v116, v118
    v_mul_f32 v120, s13, v120
    v_exp_f32 v120, v120
    v_mov_b32 v116, v118
    v_mul_f32 v121, s13, v118
    v_fma_f32 v112, v112, s13, -v121
    v_fma_f32 v113, v113, s13, -v121
    v_fma_f32 v114, v114, s13, -v121
    v_fma_f32 v115, v115, s13, -v121
    v_exp_f32 v112, v112
    v_exp_f32 v113, v113
    v_exp_f32 v114, v114
    v_exp_f32 v115, v115
    v_add_f32 v118, v112, v113
    v_add_f32 v119, v114, v115
    v_add_f32 v118, v118, v119
    v_fma_f32 v117, v117, v120, v118
    v_cvt_pk_bf16_f32 v122, v112, v113
    v_cvt_pk_bf16_f32 v123, v114, v115
    v_mul_f32 v48, v48, v120
    v_mul_f32 v49, v49, v120
    v_mul_f32 v50, v50, v120
    v_mul_f32 v51, v51, v120
    v_mul_f32 v52, v52, v120
    v_mul_f32 v53, v53, v120
    v_mul_f32 v54, v54, v120
    v_mul_f32 v55, v55, v120
    v_mul_f32 v56, v56, v120
    v_mul_f32 v57, v57, v120
    v_mul_f32 v58, v58, v120
    v_mul_f32 v59, v59, v120
    v_mul_f32 v60, v60, v120
    v_mul_f32 v61, v61, v120
    v_mul_f32 v62, v62, v120
    v_mul_f32 v63, v63, v120
    v_mul_f32 v64, v64, v120
    v_mul_f32 v65, v65, v120
    v_mul_f32 v66, v66, v120
    v_mul_f32 v67, v67, v120
    v_mul_f32 v68, v68, v120
    v_mul_f32 v69, v69, v120
    v_mul_f32 v70, v70, v120
    v_mul_f32 v71, v71, v120
    v_mul_f32 v72, v72, v120
    v_mul_f32 v73, v73, v120
    v_mul_f32 v74, v74, v120
    v_mul_f32 v75, v75, v120
    v_mul_f32 v76, v76, v120
    v_mul_f32 v77, v77, v120
    v_mul_f32 v78, v78, v120
    v_mul_f32 v79, v79, v120
    v_mfma_f32_16x16x16_bf16 v[48:51], v[96:97], v[122:123], v[48:51]
    v_mfma_f32_16x16x16_bf16 v[52:55], v[98:99], v[122:123], v[52:55]
    v_mfma_f32_16x16x16_bf16 v[56:59], v[100:101], v[122:123], v[56:59]
    v_mfma_f32_16x16x16_bf16 v[60:63], v[102:103], v[122:123], v[60:63]
    v_mfma_f32_16x16x16_bf16 v[64:67], v[104:105], v[122:123], v[64:67]
    v_mfma_f32_16x16x16_bf16 v[68:71], v[106:107], v[122:123], v[68:71]
    v_mfma_f32_16x16x16_bf16 v[72:75], v[108:109], v[122:123], v[72:75]
    v_mfma_f32_16x16x16_bf16 v[76:79], v[110:111], v[122:123], v[76:79]
    s_cmp_lg_u32 s15, 0
    s_cbranch_scc1 L_loopend
L_u1:
    s_nop 7
    s_cmp_eq_u32 s12, 0
    s_cbranch_scc1 L_w8_1
    s_waitcnt vmcnt(0)
L_w8_1:
    s_nop 7
    s_waitcnt vmcnt(8)
    ds_read_b128 v[80:83], v14 offset:8192
    ds_read_b128 v[84:87], v15 offset:8192
    ds_read_b128 v[88:91], v16 offset:8192
    ds_read_b128 v[92:95], v17 offset:8192
    ds_read_b64_tr_b16 v[96:97], v18 offset:12288
    ds_read_b64_tr_b16 v[98:99], v19 offset:12288
    ds_read_b64_tr_b16 v[100:101], v20 offset:12288
    ds_read_b64_tr_b16 v[102:103], v21 offset:12288
    ds_read_b64_tr_b16 v[104:105], v22 offset:12288
    ds_read_b64_tr_b16 v[106:107], v23 offset:12288
    ds_read_b64_tr_b16 v[108:109], v24 offset:12288
    ds_read_b64_tr_b16 v[110:111], v25 offset:12288
    s_waitcnt lgkmcnt(8)
    v_mfma_f32_16x16x32_bf16 v[112:115], v[80:83], v[32:35], 0
    v_mfma_f32_16x16x32_bf16 v[112:115], v[84:87], v[36:39], v[112:115]
    v_mfma_f32_16x16x32_bf16 v[112:115], v[88:91], v[40:43], v[112:115]
    v_mfma_f32_16x16x32_bf16 v[112:115], v[92:95], v[44:47], v[112:115]
    s_waitcnt lgkmcnt(0)
    s_mov_b32 s15, s12
    s_cmp_eq_u32 s14, 0
    s_cselect_b32 s12, 1, 0
    s_cbranch_scc1 L_noiss_1
    s_sub_u32 s14, s14, 1
    s_add_u32 m0, s10, 8192
    s_nop 0
    buffer_load_dwordx4 v8, s[44:47], s8 offen offset:0 nt lds
    buffer_load_dwordx4 v9, s[44:47], s8 offen offset:1024 nt lds
    buffer_load_dwordx4 v10, s[44:47], s8 offen offset:2048 nt lds
    buffer_load_dwordx4 v11, s[44:47], s8 offen offset:3072 nt lds
    s_add_u32 m0, s10, 12288
    s_nop 0
    buffer_load_dwordx4 v12, s[48:51], s8 offen offset:0 nt lds
    buffer_load_dwordx4 v13, s[48:51], s8 offen offset:1024 nt lds
    buffer_load_dwordx4 v12, s[48:51], s8 offen offset:2048 nt lds
    buffer_load_dwordx4 v13, s[48:51], s8 offen offset:3072 nt lds
    s_add_u32 s8, s8, 32768
L_noiss_1:
    s_nop 7
    v_max3_f32 v118, v112, v113, v114
    v_max_f32 v118, v118, v115
    v_mov_b32 v119, v118
    s_nop 1
    v_permlane16_swap_b32 v119, v118
    v_max_f32 v118, v119, v118
    v_mov_b32 v119, v118
    s_nop 1
    v_permlane32_swap_b32 v119, v118
    v_max_f32 v118, v119, v118
    v_max_f32 v118, v118, v116
    v_sub_f32 v120, v116, v118
    v_mul_f32 v120, s13, v120
    v_exp_f32 v120, v120
    v_mov_b32 v116, v118
    v_mul_f32 v121, s13, v118
    v_fma_f32 v112, v112, s13, -v121
    v_fma_f32 v113, v113, s13, -v121
    v_fma_f32 v114, v114, s13, -v121
    v_fma_f32 v115, v115, s13, -v121
    v_exp_f32 v112, v112
    v_exp_f32 v113, v113
    v_exp_f32 v114, v114
    v_exp_f32 v115, v115
    v_add_f32 v118, v112, v113
    v_add_f32 v119, v114, v115
    v_add_f32 v118, v118, v119
    v_fma_f32 v117, v117, v120, v118
    v_cvt_pk_bf16_f32 v122, v112, v113
    v_cvt_pk_bf16_f32 v123, v114, v115
    v_mul_f32 v48, v48, v120
    v_mul_f32 v49, v49, v120
    v_mul_f32 v50, v50, v120
    v_mul_f32 v51, v51, v120
    v_mul_f32 v52, v52, v120
    v_mul_f32 v53, v53, v120
    v_mul_f32 v54, v54, v120
    v_mul_f32 v55, v55, v120
    v_mul_f32 v56, v56, v120
    v_mul_f32 v57, v57, v120
    v_mul_f32 v58, v58, v120
    v_mul_f32 v59, v59, v120
    v_mul_f32 v60, v60, v120
    v_mul_f32 v61, v61, v120
    v_mul_f32 v62, v62, v120
    v_mul_f32 v63, v63, v120
    v_mul_f32 v64, v64, v120
    v_mul_f32 v65, v65, v120
    v_mul_f32 v66, v66, v120
    v_mul_f32 v67, v67, v120
    v_mul_f32 v68, v68, v120
    v_mul_f32 v69, v69, v120
    v_mul_f32 v70, v70, v120
    v_mul_f32 v71, v71, v120
    v_mul_f32 v72, v72, v120
    v_mul_f32 v73, v73, v120
    v_mul_f32 v74, v74, v120
    v_mul_f32 v75, v75, v120
    v_mul_f32 v76, v76, v120
    v_mul_f32 v77, v77, v120
    v_mul_f32 v78, v78, v120
    v_mul_f32 v79, v79, v120
    v_mfma_f32_16x16x16_bf16 v[48:51], v[96:97], v[122:123], v[48:51]
    v_mfma_f32_16x16x16_bf16 v[52:55], v[98:99], v[122:123], v[52:55]
    v_mfma_f32_16x16x16_bf16 v[56:59], v[100:101], v[122:123], v[56:59]
    v_mfma_f32_16x16x16_bf16 v[60:63], v[102:103], v[122:123], v[60:63]
    v_mfma_f32_16x16x16_bf16 v[64:67], v[104:105], v[122:123], v[64:67]
    v_mfma_f32_16x16x16_bf16 v[68:71], v[106:107], v[122:123], v[68:71]
    v_mfma_f32_16x16x16_bf16 v[72:75], v[108:109], v[122:123], v[72:75]
    v_mfma_f32_16x16x16_bf16 v[76:79], v[110:111], v[122:123], v[76:79]
    s_cmp_eq_u32 s101, 0
    s_cbranch_scc1 L_nox
    s_mov_b32 s101, 0
    v_mfma_f32_16x16x32_bf16 v[112:115], v[128:131], v[32:35], 0
    v_mfma_f32_16x16x32_bf16 v[112:115], v[132:135], v[36:39], v[112:115]
    v_mfma_f32_16x16x32_bf16 v[112:115], v[136:139], v[40:43], v[112:115]
    v_mfma_f32_16x16x32_bf16 v[112:115], v[140:143], v[44:47], v[112:115]
    s_nop 7
    v_max3_f32 v118, v112, v113, v114
    v_max_f32 v118, v118, v115
    v_mov_b32 v119, v118
    s_nop 1
    v_permlane16_swap_b32 v119, v118
    v_max_f32 v118, v119, v118
    v_mov_b32 v119, v118
    s_nop 1
    v_permlane32_swap_b32 v119, v118
    v_max_f32 v118, v119, v118
    v_max_f32 v118, v118, v116
    v_sub_f32 v120, v116, v118
    v_mul_f32 v120, s13, v120
    v_exp_f32 v120, v120
    v_mov_b32 v116, v118
    v_mul_f32 v121, s13, v118
    v_fma_f32 v112, v112, s13, -v121
    v_fma_f32 v113, v113, s13, -v121
    v_fma_f32 v114, v114, s13, -v121
    v_fma_f32 v115, v115, s13, -v121
    v_exp_f32 v112, v112
    v_exp_f32 v113, v113
    v_exp_f32 v114, v114
    v_exp_f32 v115, v115
    v_add_f32 v118, v112, v113
    v_add_f32 v119, v114, v115
    v_add_f32 v118, v118, v119
    v_fma_f32 v117, v117, v120, v118
    v_cvt_pk_bf16_f32 v122, v112, v113
    v_cvt_pk_bf16_f32 v123, v114, v115
    v_mul_f32 v48, v48, v120
    v_mul_f32 v49, v49, v120
    v_mul_f32 v50, v50, v120
    v_mul_f32 v51, v51, v120
    v_mul_f32 v52, v52, v120
    v_mul_f32 v53, v53, v120
    v_mul_f32 v54, v54, v120
    v_mul_f32 v55, v55, v120
    v_mul_f32 v56, v56, v120
    v_mul_f32 v57, v57, v120
    v_mul_f32 v58, v58, v120
    v_mul_f32 v59, v59, v120
    v_mul_f32 v60, v60, v120
    v_mul_f32 v61, v61, v120
    v_mul_f32 v62, v62, v120
    v_mul_f32 v63, v63, v120
    v_mul_f32 v64, v64, v120
    v_mul_f32 v65, v65, v120
    v_mul_f32 v66, v66, v120
    v_mul_f32 v67, v67, v120
    v_mul_f32 v68, v68, v120
    v_mul_f32 v69, v69, v120
    v_mul_f32 v70, v70, v120
    v_mul_f32 v71, v71, v120
    v_mul_f32 v72, v72, v120
    v_mul_f32 v73, v73, v120
    v_mul_f32 v74, v74, v120
    v_mul_f32 v75, v75, v120
    v_mul_f32 v76, v76, v120
    v_mul_f32 v77, v77, v120
    v_mul_f32 v78, v78, v120
    v_mul_f32 v79, v79, v120
    v_mfma_f32_16x16x16_bf16 v[48:51], v[144:145], v[122:123], v[48:51]
    v_mfma_f32_16x16x16_bf16 v[52:55], v[146:147], v[122:123], v[52:55]
    v_mfma_f32_16x16x16_bf16 v[56:59], v[148:149], v[122:123], v[56:59]
    v_mfma_f32_16x16x16_bf16 v[60:63], v[150:151], v[122:123], v[60:63]
    v_mfma_f32_16x16x16_bf16 v[64:67], v[152:153], v[122:123], v[64:67]
    v_mfma_f32_16x16x16_bf16 v[68:71], v[154:155], v[122:123], v[68:71]
    v_mfma_f32_16x16x16_bf16 v[72:75], v[156:157], v[122:123], v[72:75]
    v_mfma_f32_16x16x16_bf16 v[76:79], v[158:159], v[122:123], v[76:79]
L_nox:
    s_nop 7
    s_cmp_lg_u32 s15, 0
    s_cbranch_scc1 L_loopend
    s_branch L_loop
L_loopend:
    s_nop 7
    s_cmp_eq_u32 s42, 0
    s_cbranch_scc1 L_nomlp
    s_cmp_ge_u32 s3, 4
    s_cbranch_scc1 L_nomlp
    v_mov_b32 v118, 148992
    v_mov_b32 v119, 1
    s_lshl_b32 s94, s3, 10
    s_lshl_b32 s92, s4, 7
    buffer_load_dwordx4 v[32:35], v27, s[60:63], s94 offen
    v_lshlrev_b32 v7, 1, v1
    buffer_load_ushort v36, v7, s[76:79], s92 offen
    v_lshrrev_b32 v6, 3, v1
    v_mul_u32_u24 v6, 3584, v6
    v_and_b32 v7, 7, v1
    v_lshl_add_u32 v6, v7, 4, v6
    s_mul_i32 s9, s3, 458752
    s_add_u32 s9, s9, s92
    s_add_u32 m0, s10, 0
    s_nop 0
    buffer_load_dwordx4 v6, s[56:59], s9 offen nt lds
    s_add_u32 s9, s9, 28672
    s_add_u32 m0, s10, 1024
    s_nop 0
    buffer_load_dwordx4 v6, s[56:59], s9 offen nt lds
    s_add_u32 s9, s9, 28672
    s_add_u32 m0, s10, 2048
    s_nop 0
    buffer_load_dwordx4 v6, s[56:59], s9 offen nt lds
    s_add_u32 s9, s9, 28672
    s_add_u32 m0, s10, 3072
    s_nop 0
    buffer_load_dwordx4 v6, s[56:59], s9 offen nt lds
    s_add_u32 s9, s9, 28672
    s_add_u32 m0, s10, 4096
    s_nop 0
    buffer_load_dwordx4 v6, s[56:59], s9 offen nt lds
    s_add_u32 s9, s9, 28672
    s_add_u32 m0, s10, 5120
    s_nop 0
    buffer_load_dwordx4 v6, s[56:59], s9 offen nt lds
    s_add_u32 s9, s9, 28672
    s_add_u32 m0, s10, 6144
    s_nop 0
    buffer_load_dwordx4 v6, s[56:59], s9 offen nt lds
    s_add_u32 s9, s9, 28672
    s_add_u32 m0, s10, 7168
    s_nop 0
    buffer_load_dwordx4 v6, s[56:59], s9 offen nt lds
    s_add_u32 s9, s9, 28672
    s_add_u32 m0, s10, 8192
    s_nop 0
    buffer_load_dwordx4 v6, s[56:59], s9 offen nt lds
    s_add_u32 s9, s9, 28672
    s_add_u32 m0, s10, 9216
    s_nop 0
    buffer_load_dwordx4 v6, s[56:59], s9 offen nt lds
    s_add_u32 s9, s9, 28672
    s_add_u32 m0, s10, 10240
    s_nop 0
    buffer_load_dwordx4 v6, s[56:59], s9 offen nt lds
    s_add_u32 s9, s9, 28672
    s_add_u32 m0, s10, 11264
    s_nop 0
    buffer_load_dwordx4 v6, s[56:59], s9 offen nt lds
    s_add_u32 s9, s9, 28672
    s_add_u32 m0, s10, 12288
    s_nop 0
    buffer_load_dwordx4 v6, s[56:59], s9 offen nt lds
    s_add_u32 s9, s9, 28672
    s_add_u32 m0, s10, 13312
    s_nop 0
    buffer_load_dwordx4 v6, s[56:59], s9 offen nt lds
    s_add_u32 s9, s9, 28672
    s_add_u32 m0, s10, 14336
    s_nop 0
    buffer_load_dwordx4 v6, s[56:59], s9 offen nt lds
    s_add_u32 s9, s9, 28672
    s_add_u32 m0, s10, 15360
    s_nop 0
    buffer_load_dwordx4 v6, s[56:59], s9 offen nt lds
    s_waitcnt vmcnt(17)
    v_lshlrev_b32 v80, 16, v32
    v_and_b32 v81, 0xffff0000, v32
    v_lshlrev_b32 v82, 16, v33
    v_and_b32 v83, 0xffff0000, v33
    v_lshlrev_b32 v84, 16, v34
    v_and_b32 v85, 0xffff0000, v34
    v_lshlrev_b32 v86, 16, v35
    v_and_b32 v87, 0xffff0000, v35
    v_add_f32 v88, v80, v81
    v_add_f32 v88, v88, v82
    v_add_f32 v88, v88, v83
    v_add_f32 v88, v88, v84
    v_add_f32 v88, v88, v85
    v_add_f32 v88, v88, v86
    v_add_f32 v88, v88, v87
    s_nop 1
    v_add_f32_dpp v88, v88, v88 quad_perm:[1,0,3,2] row_mask:0xf bank_mask:0xf
    s_nop 1
    v_add_f32_dpp v88, v88, v88 quad_perm:[2,3,0,1] row_mask:0xf bank_mask:0xf
    s_nop 1
    v_add_f32_dpp v88, v88, v88 row_half_mirror row_mask:0xf bank_mask:0xf
    s_nop 1
    v_add_f32_dpp v88, v88, v88 row_mirror row_mask:0xf bank_mask:0xf
    v_mov_b32 v89, v88
    s_nop 1
    v_permlane16_swap_b32 v89, v88
    v_add_f32 v88, v89, v88
    v_mov_b32 v89, v88
    s_nop 1
    v_permlane32_swap_b32 v89, v88
    v_add_f32 v88, v89, v88
    v_mul_f32 v88, 0x3b000000, v88
    v_sub_f32 v89, v80, v88
    v_mul_f32 v91, v89, v89
    v_sub_f32 v89, v81, v88
    v_fmac_f32 v91, v89, v89
    v_sub_f32 v89, v82, v88
    v_fmac_f32 v91, v89, v89
    v_sub_f32 v89, v83, v88
    v_fmac_f32 v91, v89, v89
    v_sub_f32 v89, v84, v88
    v_fmac_f32 v91, v89, v89
    v_sub_f32 v89, v85, v88
    v_fmac_f32 v91, v89, v89
    v_sub_f32 v89, v86, v88
    v_fmac_f32 v91, v89, v89
    v_sub_f32 v89, v87, v88
    v_fmac_f32 v91, v89, v89
    s_nop 1
    v_add_f32_dpp v91, v91, v91 quad_perm:[1,0,3,2] row_mask:0xf bank_mask:0xf
    s_nop 1
    v_add_f32_dpp v91, v91, v91 quad_perm:[2,3,0,1] row_mask:0xf bank_mask:0xf
    s_nop 1
    v_add_f32_dpp v91, v91, v91 row_half_mirror row_mask:0xf bank_mask:0xf
    s_nop 1
    v_add_f32_dpp v91, v91, v91 row_mirror row_mask:0xf bank_mask:0xf
    v_mov_b32 v89, v91
    s_nop 1
    v_permlane16_swap_b32 v89, v91
    v_add_f32 v91, v89, v91
    v_mov_b32 v89, v91
    s_nop 1
    v_permlane32_swap_b32 v89, v91
    v_add_f32 v91, v89, v91
    v_mul_f32 v91, 0x3b000000, v91
    v_cvt_pk_bf16_f32 v90, v88, v88
    v_lshlrev_b32 v90, 16, v90
    v_cvt_pk_bf16_f32 v91, v91, v91
    v_lshlrev_b32 v91, 16, v91
    v_add_f32 v91, 0x3727c5ac, v91
    v_cvt_pk_bf16_f32 v91, v91, v91
    v_lshlrev_b32 v91, 16, v91
    v_sqrt_f32 v91, v91
    s_nop 0
    v_cvt_pk_bf16_f32 v91, v91, v91
    v_lshlrev_b32 v91, 16, v91
    v_rcp_f32 v91, v91
    v_sub_f32 v80, v80, v90
    v_sub_f32 v81, v81, v90
    v_cvt_pk_bf16_f32 v89, v80, v81
    v_lshlrev_b32 v80, 16, v89
    v_and_b32 v81, 0xffff0000, v89
    v_mul_f32 v80, v80, v91
    v_mul_f32 v81, v81, v91
    v_cvt_pk_bf16_f32 v96, v80, v81
    v_lshlrev_b32 v80, 16, v96
    v_and_b32 v81, 0xffff0000, v96
    v_sub_f32 v82, v82, v90
    v_sub_f32 v83, v83, v90
    v_cvt_pk_bf16_f32 v89, v82, v83
    v_lshlrev_b32 v82, 16, v89
    v_and_b32 v83, 0xffff0000, v89
    v_mul_f32 v82, v82, v91
    v_mul_f32 v83, v83, v91
    v_cvt_pk_bf16_f32 v97, v82, v83
    v_lshlrev_b32 v82, 16, v97
    v_and_b32 v83, 0xffff0000, v97
    v_sub_f32 v84, v84, v90
    v_sub_f32 v85, v85, v90
    v_cvt_pk_bf16_f32 v89, v84, v85
    v_lshlrev_b32 v84, 16, v89
    v_and_b32 v85, 0xffff0000, v89
    v_mul_f32 v84, v84, v91
    v_mul_f32 v85, v85, v91
    v_cvt_pk_bf16_f32 v98, v84, v85
    v_lshlrev_b32 v84, 16, v98
    v_and_b32 v85, 0xffff0000, v98
    v_sub_f32 v86, v86, v90
    v_sub_f32 v87, v87, v90
    v_cvt_pk_bf16_f32 v89, v86, v87
    v_lshlrev_b32 v86, 16, v89
    v_and_b32 v87, 0xffff0000, v89
    v_mul_f32 v86, v86, v91
    v_mul_f32 v87, v87, v91
    v_cvt_pk_bf16_f32 v99, v86, v87
    v_lshlrev_b32 v86, 16, v99
    v_and_b32 v87, 0xffff0000, v99
    v_add_f32 v88, v80, v81
    v_add_f32 v88, v88, v82
    v_add_f32 v88, v88, v83
    v_add_f32 v88, v88, v84
    v_add_f32 v88, v88, v85
    v_add_f32 v88, v88, v86
    v_add_f32 v88, v88, v87
    s_nop 1
    v_add_f32_dpp v88, v88, v88 quad_perm:[1,0,3,2] row_mask:0xf bank_mask:0xf
    s_nop 1
    v_add_f32_dpp v88, v88, v88 quad_perm:[2,3,0,1] row_mask:0xf bank_mask:0xf
    s_nop 1
    v_add_f32_dpp v88, v88, v88 row_half_mirror row_mask:0xf bank_mask:0xf
    s_nop 1
    v_add_f32_dpp v88, v88, v88 row_mirror row_mask:0xf bank_mask:0xf
    v_mov_b32 v89, v88
    s_nop 1
    v_permlane16_swap_b32 v89, v88
    v_add_f32 v88, v89, v88
    v_mov_b32 v89, v88
    s_nop 1
    v_permlane32_swap_b32 v89, v88
    v_add_f32 v88, v89, v88
    v_mul_f32 v88, 0x3b000000, v88
    v_sub_f32 v89, v80, v88
    v_mul_f32 v91, v89, v89
    v_sub_f32 v89, v81, v88
    v_fmac_f32 v91, v89, v89
    v_sub_f32 v89, v82, v88
    v_fmac_f32 v91, v89, v89
    v_sub_f32 v89, v83, v88
    v_fmac_f32 v91, v89, v89
    v_sub_f32 v89, v84, v88
    v_fmac_f32 v91, v89, v89
    v_sub_f32 v89, v85, v88
    v_fmac_f32 v91, v89, v89
    v_sub_f32 v89, v86, v88
    v_fmac_f32 v91, v89, v89
    v_sub_f32 v89, v87, v88
    v_fmac_f32 v91, v89, v89
    s_nop 1
    v_add_f32_dpp v91, v91, v91 quad_perm:[1,0,3,2] row_mask:0xf bank_mask:0xf
    s_nop 1
    v_add_f32_dpp v91, v91, v91 quad_perm:[2,3,0,1] row_mask:0xf bank_mask:0xf
    s_nop 1
    v_add_f32_dpp v91, v91, v91 row_half_mirror row_mask:0xf bank_mask:0xf
    s_nop 1
    v_add_f32_dpp v91, v91, v91 row_mirror row_mask:0xf bank_mask:0xf
    v_mov_b32 v89, v91
    s_nop 1
    v_permlane16_swap_b32 v89, v91
    v_add_f32 v91, v89, v91
    v_mov_b32 v89, v91
    s_nop 1
    v_permlane32_swap_b32 v89, v91
    v_add_f32 v91, v89, v91
    v_mul_f32 v91, 0x3b000000, v91
    v_cvt_pk_bf16_f32 v90, v88, v88
    v_lshlrev_b32 v90, 16, v90
    v_cvt_pk_bf16_f32 v91, v91, v91
    v_lshlrev_b32 v91, 16, v91
    v_add_f32 v91, 0x3727c5ac, v91
    v_cvt_pk_bf16_f32 v91, v91, v91
    v_lshlrev_b32 v91, 16, v91
    v_sqrt_f32 v91, v91
    s_nop 0
    v_cvt_pk_bf16_f32 v91, v91, v91
    v_lshlrev_b32 v91, 16, v91
    v_rcp_f32 v91, v91
    v_sub_f32 v80, v80, v90
    v_sub_f32 v81, v81, v90
    v_cvt_pk_bf16_f32 v89, v80, v81
    v_lshlrev_b32 v80, 16, v89
    v_and_b32 v81, 0xffff0000, v89
    v_mul_f32 v80, v80, v91
    v_mul_f32 v81, v81, v91
    v_cvt_pk_bf16_f32 v96, v80, v81
    v_lshlrev_b32 v80, 16, v96
    v_and_b32 v81, 0xffff0000, v96
    v_sub_f32 v82, v82, v90
    v_sub_f32 v83, v83, v90
    v_cvt_pk_bf16_f32 v89, v82, v83
    v_lshlrev_b32 v82, 16, v89
    v_and_b32 v83, 0xffff0000, v89
    v_mul_f32 v82, v82, v91
    v_mul_f32 v83, v83, v91
    v_cvt_pk_bf16_f32 v97, v82, v83
    v_lshlrev_b32 v82, 16, v97
    v_and_b32 v83, 0xffff0000, v97
    v_sub_f32 v84, v84, v90
    v_sub_f32 v85, v85, v90
    v_cvt_pk_bf16_f32 v89, v84, v85
    v_lshlrev_b32 v84, 16, v89
    v_and_b32 v85, 0xffff0000, v89
    v_mul_f32 v84, v84, v91
    v_mul_f32 v85, v85, v91
    v_cvt_pk_bf16_f32 v98, v84, v85
    v_lshlrev_b32 v84, 16, v98
    v_and_b32 v85, 0xffff0000, v98
    v_sub_f32 v86, v86, v90
    v_sub_f32 v87, v87, v90
    v_cvt_pk_bf16_f32 v89, v86, v87
    v_lshlrev_b32 v86, 16, v89
    v_and_b32 v87, 0xffff0000, v89
    v_mul_f32 v86, v86, v91
    v_mul_f32 v87, v87, v91
    v_cvt_pk_bf16_f32 v99, v86, v87
    v_lshlrev_b32 v86, 16, v99
    v_and_b32 v87, 0xffff0000, v99
    v_add_u32 v6, s94, v27
    v_add_u32 v6, 151552, v6
    ds_write_b128 v6, v[96:99]
    v_and_b32 v7, 3, v1
    v_lshlrev_b32 v37, 10, v7
    v_lshl_add_u32 v37, v2, 3, v37
    s_lshl_b32 s9, s3, 8
    s_add_u32 s9, s9, 151552
    v_add_u32 v37, s9, v37
    v_lshrrev_b32 v38, 2, v1
    v_lshlrev_b32 v38, 7, v38
    v_lshl_add_u32 v38, v7, 3, v38
    v_add_u32 v38, s10, v38
    v_lshlrev_b32 v39, 8, v3
    v_lshl_add_u32 v39, v2, 4, v39
    s_lshl_b32 s9, s3, 10
    s_add_u32 s9, s9, 155648
    v_add_u32 v39, s9, v39
    s_waitcnt lgkmcnt(0)
    s_mov_b64 exec, 1
    ds_add_u32 v118, v119 offset:0
    s_mov_b64 exec, -1
L_ls1:
    s_nop 7
    ds_read_b32 v120, v118 offset:0
    s_waitcnt lgkmcnt(0)
    v_readfirstlane_b32 s11, v120
    s_nop 0
    s_cmp_lt_u32 s11, 4
    s_cbranch_scc1 L_ls1
    s_waitcnt vmcnt(0)
    ds_read_b64 v[80:81], v37 offset:0
    ds_read_b64 v[82:83], v37 offset:32
    ds_read_b64 v[84:85], v37 offset:64
    ds_read_b64 v[86:87], v37 offset:96
    ds_read_b64 v[88:89], v37 offset:128
    ds_read_b64 v[90:91], v37 offset:160
    ds_read_b64 v[92:93], v37 offset:192
    ds_read_b64 v[94:95], v37 offset:224
    ds_read_b64_tr_b16 v[128:129], v38 offset:0
    ds_read_b64_tr_b16 v[130:131], v38 offset:32
    ds_read_b64_tr_b16 v[132:133], v38 offset:64
    ds_read_b64_tr_b16 v[134:135], v38 offset:96
    ds_read_b64_tr_b16 v[136:137], v38 offset:2048
    ds_read_b64_tr_b16 v[138:139], v38 offset:2080
    ds_read_b64_tr_b16 v[140:141], v38 offset:2112
    ds_read_b64_tr_b16 v[142:143], v38 offset:2144
    ds_read_b64_tr_b16 v[144:145], v38 offset:4096
    ds_read_b64_tr_b16 v[146:147], v38 offset:4128
    ds_read_b64_tr_b16 v[148:149], v38 offset:4160
    ds_read_b64_tr_b16 v[150:151], v38 offset:4192
    ds_read_b64_tr_b16 v[152:153], v38 offset:6144
    ds_read_b64_tr_b16 v[154:155], v38 offset:6176
    ds_read_b64_tr_b16 v[156:157], v38 offset:6208
    ds_read_b64_tr_b16 v[158:159], v38 offset:6240
    s_waitcnt lgkmcnt(0)
    v_mfma_f32_16x16x16_bf16 v[96:99], v[128:129], v[80:81], 0
    v_mfma_f32_16x16x16_bf16 v[100:103], v[130:131], v[80:81], 0
    v_mfma_f32_16x16x16_bf16 v[104:107], v[132:133], v[80:81], 0
    v_mfma_f32_16x16x16_bf16 v[108:111], v[134:135], v[80:81], 0
    v_mfma_f32_16x16x16_bf16 v[96:99], v[136:137], v[82:83], v[96:99]
    v_mfma_f32_16x16x16_bf16 v[100:103], v[138:139], v[82:83], v[100:103]
    v_mfma_f32_16x16x16_bf16 v[104:107], v[140:141], v[82:83], v[104:107]
    v_mfma_f32_16x16x16_bf16 v[108:111], v[142:143], v[82:83], v[108:111]
    v_mfma_f32_16x16x16_bf16 v[96:99], v[144:145], v[84:85], v[96:99]
    v_mfma_f32_16x16x16_bf16 v[100:103], v[146:147], v[84:85], v[100:103]
    v_mfma_f32_16x16x16_bf16 v[104:107], v[148:149], v[84:85], v[104:107]
    v_mfma_f32_16x16x16_bf16 v[108:111], v[150:151], v[84:85], v[108:111]
    v_mfma_f32_16x16x16_bf16 v[96:99], v[152:153], v[86:87], v[96:99]
    v_mfma_f32_16x16x16_bf16 v[100:103], v[154:155], v[86:87], v[100:103]
    v_mfma_f32_16x16x16_bf16 v[104:107], v[156:157], v[86:87], v[104:107]
    v_mfma_f32_16x16x16_bf16 v[108:111], v[158:159], v[86:87], v[108:111]
    ds_read_b64_tr_b16 v[128:129], v38 offset:8192
    ds_read_b64_tr_b16 v[130:131], v38 offset:8224
    ds_read_b64_tr_b16 v[132:133], v38 offset:8256
    ds_read_b64_tr_b16 v[134:135], v38 offset:8288
    ds_read_b64_tr_b16 v[136:137], v38 offset:10240
    ds_read_b64_tr_b16 v[138:139], v38 offset:10272
    ds_read_b64_tr_b16 v[140:141], v38 offset:10304
    ds_read_b64_tr_b16 v[142:143], v38 offset:10336
    ds_read_b64_tr_b16 v[144:145], v38 offset:12288
    ds_read_b64_tr_b16 v[146:147], v38 offset:12320
    ds_read_b64_tr_b16 v[148:149], v38 offset:12352
    ds_read_b64_tr_b16 v[150:151], v38 offset:12384
    ds_read_b64_tr_b16 v[152:153], v38 offset:14336
    ds_read_b64_tr_b16 v[154:155], v38 offset:14368
    ds_read_b64_tr_b16 v[156:157], v38 offset:14400
    ds_read_b64_tr_b16 v[158:159], v38 offset:14432
    s_waitcnt lgkmcnt(0)
    v_mfma_f32_16x16x16_bf16 v[96:99], v[128:129], v[88:89], v[96:99]
    v_mfma_f32_16x16x16_bf16 v[100:103], v[130:131], v[88:89], v[100:103]
    v_mfma_f32_16x16x16_bf16 v[104:107], v[132:133], v[88:89], v[104:107]
    v_mfma_f32_16x16x16_bf16 v[108:111], v[134:135], v[88:89], v[108:111]
    v_mfma_f32_16x16x16_bf16 v[96:99], v[136:137], v[90:91], v[96:99]
    v_mfma_f32_16x16x16_bf16 v[100:103], v[138:139], v[90:91], v[100:103]
    v_mfma_f32_16x16x16_bf16 v[104:107], v[140:141], v[90:91], v[104:107]
    v_mfma_f32_16x16x16_bf16 v[108:111], v[142:143], v[90:91], v[108:111]
    v_mfma_f32_16x16x16_bf16 v[96:99], v[144:145], v[92:93], v[96:99]
    v_mfma_f32_16x16x16_bf16 v[100:103], v[146:147], v[92:93], v[100:103]
    v_mfma_f32_16x16x16_bf16 v[104:107], v[148:149], v[92:93], v[104:107]
    v_mfma_f32_16x16x16_bf16 v[108:111], v[150:151], v[92:93], v[108:111]
    v_mfma_f32_16x16x16_bf16 v[96:99], v[152:153], v[94:95], v[96:99]
    v_mfma_f32_16x16x16_bf16 v[100:103], v[154:155], v[94:95], v[100:103]
    v_mfma_f32_16x16x16_bf16 v[104:107], v[156:157], v[94:95], v[104:107]
    v_mfma_f32_16x16x16_bf16 v[108:111], v[158:159], v[94:95], v[108:111]
    v_lshlrev_b32 v6, 10, v2
    v_lshl_add_u32 v6, v3, 4, v6
    s_lshl_b32 s9, s4, 16
    s_lshl_b32 s11, s3, 8
    s_add_u32 s9, s9, s11
    s_add_u32 m0, s10, 0
    s_nop 0
    buffer_load_dwordx4 v6, s[64:67], s9 offen nt lds
    s_add_u32 s9, s9, 4096
    s_add_u32 m0, s10, 1024
    s_nop 0
    buffer_load_dwordx4 v6, s[64:67], s9 offen nt lds
    s_add_u32 s9, s9, 4096
    s_add_u32 m0, s10, 2048
    s_nop 0
    buffer_load_dwordx4 v6, s[64:67], s9 offen nt lds
    s_add_u32 s9, s9, 4096
    s_add_u32 m0, s10, 3072
    s_nop 0
    buffer_load_dwordx4 v6, s[64:67], s9 offen nt lds
    s_add_u32 s9, s9, 4096
    s_add_u32 m0, s10, 4096
    s_nop 0
    buffer_load_dwordx4 v6, s[64:67], s9 offen nt lds
    s_add_u32 s9, s9, 4096
    s_add_u32 m0, s10, 5120
    s_nop 0
    buffer_load_dwordx4 v6, s[64:67], s9 offen nt lds
    s_add_u32 s9, s9, 4096
    s_add_u32 m0, s10, 6144
    s_nop 0
    buffer_load_dwordx4 v6, s[64:67], s9 offen nt lds
    s_add_u32 s9, s9, 4096
    s_add_u32 m0, s10, 7168
    s_nop 0
    buffer_load_dwordx4 v6, s[64:67], s9 offen nt lds
    s_add_u32 s9, s9, 4096
    s_add_u32 m0, s10, 8192
    s_nop 0
    buffer_load_dwordx4 v6, s[64:67], s9 offen nt lds
    s_add_u32 s9, s9, 4096
    s_add_u32 m0, s10, 9216
    s_nop 0
    buffer_load_dwordx4 v6, s[64:67], s9 offen nt lds
    s_add_u32 s9, s9, 4096
    s_add_u32 m0, s10, 10240
    s_nop 0
    buffer_load_dwordx4 v6, s[64:67], s9 offen nt lds
    s_add_u32 s9, s9, 4096
    s_add_u32 m0, s10, 11264
    s_nop 0
    buffer_load_dwordx4 v6, s[64:67], s9 offen nt lds
    s_add_u32 s9, s9, 4096
    s_add_u32 m0, s10, 12288
    s_nop 0
    buffer_load_dwordx4 v6, s[64:67], s9 offen nt lds
    s_add_u32 s9, s9, 4096
    s_add_u32 m0, s10, 13312
    s_nop 0
    buffer_load_dwordx4 v6, s[64:67], s9 offen nt lds
    s_add_u32 s9, s9, 4096
    s_add_u32 m0, s10, 14336
    s_nop 0
    buffer_load_dwordx4 v6, s[64:67], s9 offen nt lds
    s_add_u32 s9, s9, 4096
    s_add_u32 m0, s10, 15360
    s_nop 0
    buffer_load_dwordx4 v6, s[64:67], s9 offen nt lds
    v_cmp_gt_u32 vcc, 4, v3
    s_nop 0
    s_and_saveexec_b64 s[86:87], vcc
    ds_write_b128 v39, v[96:99] offset:0
    ds_write_b128 v39, v[100:103] offset:64
    ds_write_b128 v39, v[104:107] offset:128
    ds_write_b128 v39, v[108:111] offset:192
    s_mov_b64 exec, s[86:87]
    s_waitcnt lgkmcnt(0)
    s_mov_b64 exec, 1
    ds_add_u32 v118, v119 offset:4
    s_mov_b64 exec, -1
L_ls2:
    s_nop 7
    ds_read_b32 v120, v118 offset:4
    s_waitcnt lgkmcnt(0)
    v_readfirstlane_b32 s11, v120
    s_nop 0
    s_cmp_lt_u32 s11, 4
    s_cbranch_scc1 L_ls2
    v_lshlrev_b32 v6, 2, v1
    s_lshl_b32 s9, s3, 8
    s_add_u32 s9, s9, 155648
    v_add_u32 v6, s9, v6
    ds_read_b32 v80, v6 offset:0
    ds_read_b32 v81, v6 offset:1024
    ds_read_b32 v82, v6 offset:2048
    ds_read_b32 v83, v6 offset:3072
    s_waitcnt lgkmcnt(0)
    v_add_f32 v80, v80, v81
    v_add_f32 v80, v80, v82
    v_add_f32 v80, v80, v83
    v_cvt_pk_bf16_f32 v80, v80, v80
    v_lshlrev_b32 v80, 16, v80
    v_lshlrev_b32 v36, 16, v36
    v_add_f32 v80, v80, v36
    v_cvt_pk_bf16_f32 v80, v80, v80
    v_lshlrev_b32 v80, 16, v80
    v_mul_f32 v81, v80, v80
    v_mul_f32 v81, 0x3d372713, v81
    v_fma_f32 v81, v81, v80, v80
    v_mul_f32 v81, 0xc0135761, v81
    v_exp_f32 v81, v81
    s_nop 0
    v_add_f32 v81, 1.0, v81
    v_rcp_f32 v81, v81
    s_nop 0
    v_mul_f32 v80, v80, v81
    v_cvt_pk_bf16_f32 v81, v80, v80
    v_lshlrev_b32 v6, 1, v1
    s_lshl_b32 s9, s3, 7
    s_add_u32 s9, s9, 149504
    v_add_u32 v6, s9, v6
    ds_write_b16 v6, v81
    s_waitcnt lgkmcnt(0)
    s_mov_b64 exec, 1
    ds_add_u32 v118, v119 offset:8
    s_mov_b64 exec, -1
L_ls3:
    s_nop 7
    ds_read_b32 v120, v118 offset:8
    s_waitcnt lgkmcnt(0)
    v_readfirstlane_b32 s11, v120
    s_nop 0
    s_cmp_lt_u32 s11, 4
    s_cbranch_scc1 L_ls3
    v_and_b32 v7, 3, v1
    v_lshlrev_b32 v37, 7, v7
    v_lshl_add_u32 v37, v2, 3, v37
    v_add_u32 v37, 149504, v37
    v_lshrrev_b32 v38, 2, v1
    v_lshlrev_b32 v38, 8, v38
    v_lshl_add_u32 v38, v7, 3, v38
    v_add_u32 v38, s10, v38
    v_add_u32 v40, 1, v170
    v_lshlrev_b32 v6, 12, v3
    v_lshl_add_u32 v6, v2, 5, v6
    s_waitcnt vmcnt(0)
    ds_read_b64 v[80:81], v37 offset:0
    ds_read_b64 v[82:83], v37 offset:32
    ds_read_b64 v[84:85], v37 offset:64
    ds_read_b64 v[86:87], v37 offset:96
    ds_read_b64_tr_b16 v[128:129], v38 offset:0
    ds_read_b64_tr_b16 v[130:131], v38 offset:32
    ds_read_b64_tr_b16 v[132:133], v38 offset:64
    ds_read_b64_tr_b16 v[134:135], v38 offset:96
    ds_read_b64_tr_b16 v[136:137], v38 offset:4096
    ds_read_b64_tr_b16 v[138:139], v38 offset:4128
    ds_read_b64_tr_b16 v[140:141], v38 offset:4160
    ds_read_b64_tr_b16 v[142:143], v38 offset:4192
    ds_read_b64_tr_b16 v[144:145], v38 offset:8192
    ds_read_b64_tr_b16 v[146:147], v38 offset:8224
    ds_read_b64_tr_b16 v[148:149], v38 offset:8256
    ds_read_b64_tr_b16 v[150:151], v38 offset:8288
    ds_read_b64_tr_b16 v[152:153], v38 offset:12288
    ds_read_b64_tr_b16 v[154:155], v38 offset:12320
    ds_read_b64_tr_b16 v[156:157], v38 offset:12352
    ds_read_b64_tr_b16 v[158:159], v38 offset:12384
    s_waitcnt lgkmcnt(0)
    v_mfma_f32_16x16x16_bf16 v[96:99], v[128:129], v[80:81], 0
    v_mfma_f32_16x16x16_bf16 v[100:103], v[130:131], v[80:81], 0
    v_mfma_f32_16x16x16_bf16 v[104:107], v[132:133], v[80:81], 0
    v_mfma_f32_16x16x16_bf16 v[108:111], v[134:135], v[80:81], 0
    v_mfma_f32_16x16x16_bf16 v[96:99], v[136:137], v[82:83], v[96:99]
    v_mfma_f32_16x16x16_bf16 v[100:103], v[138:139], v[82:83], v[100:103]
    v_mfma_f32_16x16x16_bf16 v[104:107], v[140:141], v[82:83], v[104:107]
    v_mfma_f32_16x16x16_bf16 v[108:111], v[142:143], v[82:83], v[108:111]
    v_mfma_f32_16x16x16_bf16 v[96:99], v[144:145], v[84:85], v[96:99]
    v_mfma_f32_16x16x16_bf16 v[100:103], v[146:147], v[84:85], v[100:103]
    v_mfma_f32_16x16x16_bf16 v[104:107], v[148:149], v[84:85], v[104:107]
    v_mfma_f32_16x16x16_bf16 v[108:111], v[150:151], v[84:85], v[108:111]
    v_mfma_f32_16x16x16_bf16 v[96:99], v[152:153], v[86:87], v[96:99]
    v_mfma_f32_16x16x16_bf16 v[100:103], v[154:155], v[86:87], v[100:103]
    v_mfma_f32_16x16x16_bf16 v[104:107], v[156:157], v[86:87], v[104:107]
    v_mfma_f32_16x16x16_bf16 v[108:111], v[158:159], v[86:87], v[108:111]
    s_lshl_b32 s9, s4, 14
    s_lshl_b32 s11, s3, 10
    s_add_u32 s9, s9, s11
    s_add_u32 s9, s9, 8388608
    s_nop 0
    v_mov_b32 v128, v96
    v_mov_b32 v129, v40
    v_mov_b32 v130, v97
    v_mov_b32 v131, v40
    v_mov_b32 v132, v98
    v_mov_b32 v133, v40
    v_mov_b32 v134, v99
    v_mov_b32 v135, v40
    v_mov_b32 v136, v100
    v_mov_b32 v137, v40
    v_mov_b32 v138, v101
    v_mov_b32 v139, v40
    v_mov_b32 v140, v102
    v_mov_b32 v141, v40
    v_mov_b32 v142, v103
    v_mov_b32 v143, v40
    v_mov_b32 v144, v104
    v_mov_b32 v145, v40
    v_mov_b32 v146, v105
    v_mov_b32 v147, v40
    v_mov_b32 v148, v106
    v_mov_b32 v149, v40
    v_mov_b32 v150, v107
    v_mov_b32 v151, v40
    v_mov_b32 v152, v108
    v_mov_b32 v153, v40
    v_mov_b32 v154, v109
    v_mov_b32 v155, v40
    v_mov_b32 v156, v110
    v_mov_b32 v157, v40
    v_mov_b32 v158, v111
    v_mov_b32 v159, v40
    v_cmp_gt_u32 vcc, 4, v3
    s_nop 0
    s_and_saveexec_b64 s[86:87], vcc
    buffer_store_dwordx4 v[128:131], v6, s[52:55], s9 offen offset:0 sc1
    buffer_store_dwordx4 v[132:135], v6, s[52:55], s9 offen offset:16 sc1
    buffer_store_dwordx4 v[136:139], v6, s[52:55], s9 offen offset:128 sc1
    buffer_store_dwordx4 v[140:143], v6, s[52:55], s9 offen offset:144 sc1
    buffer_store_dwordx4 v[144:147], v6, s[52:55], s9 offen offset:256 sc1
    buffer_store_dwordx4 v[148:151], v6, s[52:55], s9 offen offset:272 sc1
    buffer_store_dwordx4 v[152:155], v6, s[52:55], s9 offen offset:384 sc1
    buffer_store_dwordx4 v[156:159], v6, s[52:55], s9 offen offset:400 sc1
    s_mov_b64 exec, s[86:87]
    s_waitcnt vmcnt(0)
    ds_read_b64_tr_b16 v[128:129], v38 offset:128
    ds_read_b64_tr_b16 v[130:131], v38 offset:160
    ds_read_b64_tr_b16 v[132:133], v38 offset:192
    ds_read_b64_tr_b16 v[134:135], v38 offset:224
    ds_read_b64_tr_b16 v[136:137], v38 offset:4224
    ds_read_b64_tr_b16 v[138:139], v38 offset:4256
    ds_read_b64_tr_b16 v[140:141], v38 offset:4288
    ds_read_b64_tr_b16 v[142:143], v38 offset:4320
    ds_read_b64_tr_b16 v[144:145], v38 offset:8320
    ds_read_b64_tr_b16 v[146:147], v38 offset:8352
    ds_read_b64_tr_b16 v[148:149], v38 offset:8384
    ds_read_b64_tr_b16 v[150:151], v38 offset:8416
    ds_read_b64_tr_b16 v[152:153], v38 offset:12416
    ds_read_b64_tr_b16 v[154:155], v38 offset:12448
    ds_read_b64_tr_b16 v[156:157], v38 offset:12480
    ds_read_b64_tr_b16 v[158:159], v38 offset:12512
    s_waitcnt lgkmcnt(0)
    v_mfma_f32_16x16x16_bf16 v[96:99], v[128:129], v[80:81], 0
    v_mfma_f32_16x16x16_bf16 v[100:103], v[130:131], v[80:81], 0
    v_mfma_f32_16x16x16_bf16 v[104:107], v[132:133], v[80:81], 0
    v_mfma_f32_16x16x16_bf16 v[108:111], v[134:135], v[80:81], 0
    v_mfma_f32_16x16x16_bf16 v[96:99], v[136:137], v[82:83], v[96:99]
    v_mfma_f32_16x16x16_bf16 v[100:103], v[138:139], v[82:83], v[100:103]
    v_mfma_f32_16x16x16_bf16 v[104:107], v[140:141], v[82:83], v[104:107]
    v_mfma_f32_16x16x16_bf16 v[108:111], v[142:143], v[82:83], v[108:111]
    v_mfma_f32_16x16x16_bf16 v[96:99], v[144:145], v[84:85], v[96:99]
    v_mfma_f32_16x16x16_bf16 v[100:103], v[146:147], v[84:85], v[100:103]
    v_mfma_f32_16x16x16_bf16 v[104:107], v[148:149], v[84:85], v[104:107]
    v_mfma_f32_16x16x16_bf16 v[108:111], v[150:151], v[84:85], v[108:111]
    v_mfma_f32_16x16x16_bf16 v[96:99], v[152:153], v[86:87], v[96:99]
    v_mfma_f32_16x16x16_bf16 v[100:103], v[154:155], v[86:87], v[100:103]
    v_mfma_f32_16x16x16_bf16 v[104:107], v[156:157], v[86:87], v[104:107]
    v_mfma_f32_16x16x16_bf16 v[108:111], v[158:159], v[86:87], v[108:111]
    s_lshl_b32 s9, s4, 14
    s_lshl_b32 s11, s3, 10
    s_add_u32 s9, s9, s11
    s_add_u32 s9, s9, 8389120
    s_nop 0
    v_mov_b32 v128, v96
    v_mov_b32 v129, v40
    v_mov_b32 v130, v97
    v_mov_b32 v131, v40
    v_mov_b32 v132, v98
    v_mov_b32 v133, v40
    v_mov_b32 v134, v99
    v_mov_b32 v135, v40
    v_mov_b32 v136, v100
    v_mov_b32 v137, v40
    v_mov_b32 v138, v101
    v_mov_b32 v139, v40
    v_mov_b32 v140, v102
    v_mov_b32 v141, v40
    v_mov_b32 v142, v103
    v_mov_b32 v143, v40
    v_mov_b32 v144, v104
    v_mov_b32 v145, v40
    v_mov_b32 v146, v105
    v_mov_b32 v147, v40
    v_mov_b32 v148, v106
    v_mov_b32 v149, v40
    v_mov_b32 v150, v107
    v_mov_b32 v151, v40
    v_mov_b32 v152, v108
    v_mov_b32 v153, v40
    v_mov_b32 v154, v109
    v_mov_b32 v155, v40
    v_mov_b32 v156, v110
    v_mov_b32 v157, v40
    v_mov_b32 v158, v111
    v_mov_b32 v159, v40
    v_cmp_gt_u32 vcc, 4, v3
    s_nop 0
    s_and_saveexec_b64 s[86:87], vcc
    buffer_store_dwordx4 v[128:131], v6, s[52:55], s9 offen offset:0 sc1
    buffer_store_dwordx4 v[132:135], v6, s[52:55], s9 offen offset:16 sc1
    buffer_store_dwordx4 v[136:139], v6, s[52:55], s9 offen offset:128 sc1
    buffer_store_dwordx4 v[140:143], v6, s[52:55], s9 offen offset:144 sc1
    buffer_store_dwordx4 v[144:147], v6, s[52:55], s9 offen offset:256 sc1
    buffer_store_dwordx4 v[148:151], v6, s[52:55], s9 offen offset:272 sc1
    buffer_store_dwordx4 v[152:155], v6, s[52:55], s9 offen offset:384 sc1
    buffer_store_dwordx4 v[156:159], v6, s[52:55], s9 offen offset:400 sc1
    s_mov_b64 exec, s[86:87]
L_nomlp:
    s_nop 7
    v_mov_b32 v119, v117
    s_nop 1
    v_permlane16_swap_b32 v119, v117
    v_add_f32 v117, v119, v117
    v_mov_b32 v119, v117
    s_nop 1
    v_permlane32_swap_b32 v119, v117
    v_add_f32 v117, v119, v117
    v_lshlrev_b32 v6, 9, v3
    v_lshl_add_u32 v6, v2, 4, v6
    v_add_u32 v6, s10, v6
    v_lshlrev_b32 v7, 3, v3
    v_add_u32 v7, s10, v7
    v_cmp_gt_u32 vcc, 4, v3
    s_nop 0
    s_and_saveexec_b64 s[86:87], vcc
    ds_write_b128 v6, v[48:51] offset:0
    ds_write_b128 v6, v[52:55] offset:64
    ds_write_b128 v6, v[56:59] offset:128
    ds_write_b128 v6, v[60:63] offset:192
    ds_write_b128 v6, v[64:67] offset:256
    ds_write_b128 v6, v[68:71] offset:320
    ds_write_b128 v6, v[72:75] offset:384
    ds_write_b128 v6, v[76:79] offset:448
    ds_write_b64 v7, v[116:117] offset:2048
    s_mov_b64 exec, s[86:87]
    v_lshrrev_b32 v6, 7, v0
    v_and_b32 v7, 127, v0
    v_lshlrev_b32 v8, 9, v6
    v_lshl_add_u32 v8, v7, 2, v8
    v_lshlrev_b32 v9, 3, v6
    v_add_u32 v10, 0x10000, v8
    v_add_u32 v11, 0x10000, v9
    s_waitcnt lgkmcnt(0)
    s_barrier
    ds_read_b32 v32, v8 offset:0
    ds_read_b64 v[40:41], v9 offset:2048
    ds_read_b32 v33, v8 offset:16384
    ds_read_b64 v[42:43], v9 offset:18432
    ds_read_b32 v34, v8 offset:32768
    ds_read_b64 v[44:45], v9 offset:34816
    ds_read_b32 v35, v8 offset:49152
    ds_read_b64 v[46:47], v9 offset:51200
    ds_read_b32 v36, v10 offset:0
    ds_read_b64 v[48:49], v11 offset:2048
    ds_read_b32 v37, v10 offset:16384
    ds_read_b64 v[50:51], v11 offset:18432
    ds_read_b32 v38, v10 offset:32768
    ds_read_b64 v[52:53], v11 offset:34816
    ds_read_b32 v39, v10 offset:49152
    ds_read_b64 v[54:55], v11 offset:51200
    s_waitcnt lgkmcnt(0)
    v_max3_f32 v12, v40, v42, v44
    v_max3_f32 v12, v12, v46, v48
    v_max3_f32 v12, v12, v50, v52
    v_max_f32 v12, v12, v54
    v_mov_b32 v14, 0
    v_mov_b32 v13, 0
    v_sub_f32 v15, v40, v12
    v_mul_f32 v15, s13, v15
    v_exp_f32 v15, v15
    s_nop 0
    v_fmac_f32 v14, v15, v32
    v_fmac_f32 v13, v15, v41
    v_sub_f32 v15, v42, v12
    v_mul_f32 v15, s13, v15
    v_exp_f32 v15, v15
    s_nop 0
    v_fmac_f32 v14, v15, v33
    v_fmac_f32 v13, v15, v43
    v_sub_f32 v15, v44, v12
    v_mul_f32 v15, s13, v15
    v_exp_f32 v15, v15
    s_nop 0
    v_fmac_f32 v14, v15, v34
    v_fmac_f32 v13, v15, v45
    v_sub_f32 v15, v46, v12
    v_mul_f32 v15, s13, v15
    v_exp_f32 v15, v15
    s_nop 0
    v_fmac_f32 v14, v15, v35
    v_fmac_f32 v13, v15, v47
    v_sub_f32 v15, v48, v12
    v_mul_f32 v15, s13, v15
    v_exp_f32 v15, v15
    s_nop 0
    v_fmac_f32 v14, v15, v36
    v_fmac_f32 v13, v15, v49
    v_sub_f32 v15, v50, v12
    v_mul_f32 v15, s13, v15
    v_exp_f32 v15, v15
    s_nop 0
    v_fmac_f32 v14, v15, v37
    v_fmac_f32 v13, v15, v51
    v_sub_f32 v15, v52, v12
    v_mul_f32 v15, s13, v15
    v_exp_f32 v15, v15
    s_nop 0
    v_fmac_f32 v14, v15, v38
    v_fmac_f32 v13, v15, v53
    v_sub_f32 v15, v54, v12
    v_mul_f32 v15, s13, v15
    v_exp_f32 v15, v15
    s_nop 0
    v_fmac_f32 v14, v15, v39
    v_fmac_f32 v13, v15, v55
    v_add_u32 v60, 1, v170
    v_mov_b32 v15, v60
    buffer_store_dwordx2 v[14:15], v28, s[52:55], s84 offen sc1
    v_mul_f32 v56, s13, v12
    v_mov_b32 v57, v60
    v_mov_b32 v58, v13
    v_mov_b32 v59, v60
    v_cmp_eq_u32 vcc, 0, v7
    s_nop 0
    s_and_saveexec_b64 s[86:87], vcc
    buffer_store_dwordx4 v[56:59], v29, s[52:55], s84 offen sc1
    s_mov_b64 exec, s[86:87]
    s_mov_b32 s9, 294912
    v_mul_lo_u32 v10, v6, s9
    v_lshl_add_u32 v11, v7, 3, v10
    v_add_u32 v10, 1024, v10
    s_mul_i32 s9, s4, 9216
    s_add_u32 s9, s9, 5242880
    s_add_u32 s15, s9, 4608
    v_lshlrev_b32 v15, 1, v0
    v_add_u32 v15, 150528, v15
    v_and_b32 v14, 3, v1
    v_lshlrev_b32 v16, 8, v14
    v_lshl_add_u32 v16, v2, 3, v16
    v_add_u32 v16, 150528, v16
    v_lshrrev_b32 v17, 2, v1
    v_lshlrev_b32 v17, 7, v17
    v_lshl_add_u32 v17, v14, 3, v17
    s_and_b32 s11, s3, 3
    s_lshl_b32 s11, s11, 5
    s_add_u32 s11, s11, 131072
    v_add_u32 v17, s11, v17
    ds_read_b64_tr_b16 v[128:129], v17 offset:0
    ds_read_b64_tr_b16 v[130:131], v17 offset:2048
    ds_read_b64_tr_b16 v[132:133], v17 offset:4096
    ds_read_b64_tr_b16 v[134:135], v17 offset:6144
    ds_read_b64_tr_b16 v[136:137], v17 offset:8192
    ds_read_b64_tr_b16 v[138:139], v17 offset:10240
    ds_read_b64_tr_b16 v[140:141], v17 offset:12288
    ds_read_b64_tr_b16 v[142:143], v17 offset:14336
    v_lshlrev_b32 v18, 9, v3
    v_lshl_add_u32 v18, v2, 4, v18
    s_and_b32 s11, s3, 3
    s_lshl_b32 s11, s11, 7
    v_add_u32 v18, s11, v18
    s_cmp_lt_u32 s2, 224
    s_cbranch_scc1 L_s3pre_done
    s_and_b32 s6, s4, 3
    v_lshlrev_b32 v5, 3, v1
    v_lshlrev_b32 v6, 1, v1
    s_lshl_b32 s92, s3, 14
    s_lshl_b32 s11, s6, 12
    s_add_u32 s92, s92, s11
    s_lshl_b32 s11, s5, 9
    s_add_u32 s92, s92, s11
    s_add_u32 s92, s92, 8388608
    s_add_u32 s88, s92, 131072
    s_add_u32 s89, s92, 262144
    s_add_u32 s90, s92, 393216
    s_cmp_lt_u32 s3, 4
    s_cselect_b32 s90, s90, s92
    s_mov_b32 s76, s34
    s_mov_b32 s77, s35
    s_mov_b32 s78, 1024
    s_mov_b32 s79, 0x20000
    s_lshl_b32 s11, s5, 7
    buffer_load_ushort v152, v6, s[76:79], s11 offen
    s_lshl_b32 s94, s6, 10
    s_add_u32 s94, s94, s11
    buffer_load_ushort v153, v6, s[60:63], s94 offen
    buffer_load_dwordx2 v[144:145], v5, s[52:55], s92 offen sc1
    buffer_load_dwordx2 v[146:147], v5, s[52:55], s88 offen sc1
    buffer_load_dwordx2 v[148:149], v5, s[52:55], s89 offen sc1
    buffer_load_dwordx2 v[150:151], v5, s[52:55], s90 offen sc1
    s_lshl_b32 s93, s5, 16
    s_lshl_b32 s11, s3, 13
    s_add_u32 s93, s93, s11
    s_lshl_b32 s11, s6, 9
    s_add_u32 s93, s93, s11
    s_add_u32 s93, s93, 7340032
    s_add_u32 s91, s93, 4096
    v_lshlrev_b32 v4, 7, v2
    v_bfe_u32 v7, v1, 1, 1
    v_lshl_add_u32 v4, v7, 6, v4
    v_bfe_u32 v7, v1, 2, 2
    v_lshl_add_u32 v4, v7, 4, v4
    v_and_b32 v7, 1, v1
    v_lshl_add_u32 v4, v7, 3, v4
L_s3pre_done:
    s_nop 7
    v_and_b32 v21, 7, v1
    v_mul_u32_u24 v21, 1152, v21
    v_add_u32 v21, v21, v10
    s_mov_b32 s14, 0
    s_mov_b32 s12, 0
L_s2poll:
    s_nop 7
    s_bitcmp1_b32 s12, 0
    s_cbranch_scc1 L_s2sk0
    buffer_load_dwordx4 v[88:91], v10, s[52:55], s9 offen offset:0 sc1
    buffer_load_dwordx2 v[72:73], v11, s[52:55], s9 offen offset:0 sc1
L_s2sk0:
    s_bitcmp1_b32 s12, 1
    s_cbranch_scc1 L_s2sk1
    buffer_load_dwordx4 v[92:95], v10, s[52:55], s9 offen offset:1152 sc1
    buffer_load_dwordx2 v[74:75], v11, s[52:55], s9 offen offset:1152 sc1
L_s2sk1:
    s_bitcmp1_b32 s12, 2
    s_cbranch_scc1 L_s2sk2
    buffer_load_dwordx4 v[96:99], v10, s[52:55], s9 offen offset:2304 sc1
    buffer_load_dwordx2 v[76:77], v11, s[52:55], s9 offen offset:2304 sc1
L_s2sk2:
    s_bitcmp1_b32 s12, 3
    s_cbranch_scc1 L_s2sk3
    buffer_load_dwordx4 v[100:103], v10, s[52:55], s9 offen offset:3456 sc1
    buffer_load_dwordx2 v[78:79], v11, s[52:55], s9 offen offset:3456 sc1
L_s2sk3:
    s_bitcmp1_b32 s12, 4
    s_cbranch_scc1 L_s2sk4
    buffer_load_dwordx4 v[104:107], v10, s[52:55], s15 offen offset:0 sc1
    buffer_load_dwordx2 v[80:81], v11, s[52:55], s15 offen offset:0 sc1
L_s2sk4:
    s_bitcmp1_b32 s12, 5
    s_cbranch_scc1 L_s2sk5
    buffer_load_dwordx4 v[108:111], v10, s[52:55], s15 offen offset:1152 sc1
    buffer_load_dwordx2 v[82:83], v11, s[52:55], s15 offen offset:1152 sc1
L_s2sk5:
    s_bitcmp1_b32 s12, 6
    s_cbranch_scc1 L_s2sk6
    buffer_load_dwordx4 v[112:115], v10, s[52:55], s15 offen offset:2304 sc1
    buffer_load_dwordx2 v[84:85], v11, s[52:55], s15 offen offset:2304 sc1
L_s2sk6:
    s_bitcmp1_b32 s12, 7
    s_cbranch_scc1 L_s2sk7
    buffer_load_dwordx4 v[116:119], v10, s[52:55], s15 offen offset:3456 sc1
    buffer_load_dwordx2 v[86:87], v11, s[52:55], s15 offen offset:3456 sc1
L_s2sk7:
    s_waitcnt vmcnt(0)
    v_xor_b32 v12, v89, v60
    v_xor_b32 v13, v91, v60
    v_xor_b32 v14, v73, v60
    v_or3_b32 v12, v12, v13, v14
    v_cmp_eq_u32 vcc, 0, v12
    s_nop 0
    s_cmp_eq_u64 vcc, exec
    s_cselect_b32 s11, 1, 0
    s_or_b32 s12, s12, s11
    v_xor_b32 v12, v93, v60
    v_xor_b32 v13, v95, v60
    v_xor_b32 v14, v75, v60
    v_or3_b32 v12, v12, v13, v14
    v_cmp_eq_u32 vcc, 0, v12
    s_nop 0
    s_cmp_eq_u64 vcc, exec
    s_cselect_b32 s11, 2, 0
    s_or_b32 s12, s12, s11
    v_xor_b32 v12, v97, v60
    v_xor_b32 v13, v99, v60
    v_xor_b32 v14, v77, v60
    v_or3_b32 v12, v12, v13, v14
    v_cmp_eq_u32 vcc, 0, v12
    s_nop 0
    s_cmp_eq_u64 vcc, exec
    s_cselect_b32 s11, 4, 0
    s_or_b32 s12, s12, s11
    v_xor_b32 v12, v101, v60
    v_xor_b32 v13, v103, v60
    v_xor_b32 v14, v79, v60
    v_or3_b32 v12, v12, v13, v14
    v_cmp_eq_u32 vcc, 0, v12
    s_nop 0
    s_cmp_eq_u64 vcc, exec
    s_cselect_b32 s11, 8, 0
    s_or_b32 s12, s12, s11
    v_xor_b32 v12, v105, v60
    v_xor_b32 v13, v107, v60
    v_xor_b32 v14, v81, v60
    v_or3_b32 v12, v12, v13, v14
    v_cmp_eq_u32 vcc, 0, v12
    s_nop 0
    s_cmp_eq_u64 vcc, exec
    s_cselect_b32 s11, 16, 0
    s_or_b32 s12, s12, s11
    v_xor_b32 v12, v109, v60
    v_xor_b32 v13, v111, v60
    v_xor_b32 v14, v83, v60
    v_or3_b32 v12, v12, v13, v14
    v_cmp_eq_u32 vcc, 0, v12
    s_nop 0
    s_cmp_eq_u64 vcc, exec
    s_cselect_b32 s11, 32, 0
    s_or_b32 s12, s12, s11
    v_xor_b32 v12, v113, v60
    v_xor_b32 v13, v115, v60
    v_xor_b32 v14, v85, v60
    v_or3_b32 v12, v12, v13, v14
    v_cmp_eq_u32 vcc, 0, v12
    s_nop 0
    s_cmp_eq_u64 vcc, exec
    s_cselect_b32 s11, 64, 0
    s_or_b32 s12, s12, s11
    v_xor_b32 v12, v117, v60
    v_xor_b32 v13, v119, v60
    v_xor_b32 v14, v87, v60
    v_or3_b32 v12, v12, v13, v14
    v_cmp_eq_u32 vcc, 0, v12
    s_nop 0
    s_cmp_eq_u64 vcc, exec
    s_cselect_b32 s11, 128, 0
    s_or_b32 s12, s12, s11
    s_cmp_eq_u32 s12, 0xff
    s_cbranch_scc1 L_s2go
    s_add_u32 s14, s14, 1
    s_cmp_ge_u32 s14, 1048576
    s_cbranch_scc1 L_s2go
    s_bcnt1_i32_b32 s11, s12
    s_cmp_lt_u32 s11, 7
    s_cbranch_scc1 L_s2lite
    s_sleep 1
    s_branch L_s2poll
L_s2lite:
    s_nop 7
    s_xor_b32 s11, s12, 0xff
    s_mov_b32 exec_lo, s11
    s_mov_b32 exec_hi, 0
L_s2pre:
    s_nop 7
    s_sleep 8
    buffer_load_dwordx2 v[24:25], v21, s[52:55], s9 offen sc1
    s_waitcnt vmcnt(0)
    v_cmp_ne_u32 vcc, v25, v60
    s_nop 0
    s_and_b64 exec, exec, vcc
    s_bcnt1_i32_b32 s11, exec_lo
    s_cmp_le_u32 s11, 1
    s_cbranch_scc1 L_s2pre_done
    s_add_u32 s14, s14, 1
    s_cmp_lt_u32 s14, 1048576
    s_cbranch_scc1 L_s2pre
L_s2pre_done:
    s_nop 7
    s_mov_b64 exec, -1
    s_branch L_s2poll
L_s2go:
    s_nop 7
    v_max3_f32 v12, v88, v92, v96
    v_max3_f32 v12, v12, v100, v104
    v_max3_f32 v12, v12, v108, v112
    v_max_f32 v12, v12, v116
    v_mov_b32 v13, 0
    v_mov_b32 v14, 0
    v_sub_f32 v40, v88, v12
    v_exp_f32 v40, v40
    v_sub_f32 v41, v92, v12
    v_exp_f32 v41, v41
    v_sub_f32 v42, v96, v12
    v_exp_f32 v42, v42
    v_sub_f32 v43, v100, v12
    v_exp_f32 v43, v43
    v_sub_f32 v44, v104, v12
    v_exp_f32 v44, v44
    v_sub_f32 v45, v108, v12
    v_exp_f32 v45, v45
    v_sub_f32 v46, v112, v12
    v_exp_f32 v46, v46
    v_sub_f32 v47, v116, v12
    v_exp_f32 v47, v47
    v_fmac_f32 v13, v40, v72
    v_fmac_f32 v14, v40, v90
    v_fmac_f32 v13, v41, v74
    v_fmac_f32 v14, v41, v94
    v_fmac_f32 v13, v42, v76
    v_fmac_f32 v14, v42, v98
    v_fmac_f32 v13, v43, v78
    v_fmac_f32 v14, v43, v102
    v_fmac_f32 v13, v44, v80
    v_fmac_f32 v14, v44, v106
    v_fmac_f32 v13, v45, v82
    v_fmac_f32 v14, v45, v110
    v_fmac_f32 v13, v46, v84
    v_fmac_f32 v14, v46, v114
    v_fmac_f32 v13, v47, v86
    v_fmac_f32 v14, v47, v118
    v_rcp_f32 v14, v14
    s_nop 0
    v_mul_f32 v13, v13, v14
    v_cvt_pk_bf16_f32 v13, v13, v13
    ds_write_b16 v15, v13
    s_waitcnt lgkmcnt(0)
    s_barrier
    s_cmp_ge_u32 s3, 4
    s_cbranch_scc1 L_s3
    ds_read_b64 v[72:73], v16 offset:0
    ds_read_b64 v[74:75], v16 offset:32
    ds_read_b64 v[76:77], v16 offset:64
    ds_read_b64 v[78:79], v16 offset:96
    ds_read_b64 v[80:81], v16 offset:128
    ds_read_b64 v[82:83], v16 offset:160
    ds_read_b64 v[84:85], v16 offset:192
    ds_read_b64 v[86:87], v16 offset:224
    s_waitcnt lgkmcnt(7)
    v_mfma_f32_16x16x16_bf16 v[32:35], v[128:129], v[72:73], 0
    s_waitcnt lgkmcnt(6)
    v_mfma_f32_16x16x16_bf16 v[32:35], v[130:131], v[74:75], v[32:35]
    s_waitcnt lgkmcnt(5)
    v_mfma_f32_16x16x16_bf16 v[32:35], v[132:133], v[76:77], v[32:35]
    s_waitcnt lgkmcnt(4)
    v_mfma_f32_16x16x16_bf16 v[32:35], v[134:135], v[78:79], v[32:35]
    s_waitcnt lgkmcnt(3)
    v_mfma_f32_16x16x16_bf16 v[32:35], v[136:137], v[80:81], v[32:35]
    s_waitcnt lgkmcnt(2)
    v_mfma_f32_16x16x16_bf16 v[32:35], v[138:139], v[82:83], v[32:35]
    s_waitcnt lgkmcnt(1)
    v_mfma_f32_16x16x16_bf16 v[32:35], v[140:141], v[84:85], v[32:35]
    s_waitcnt lgkmcnt(0)
    v_mfma_f32_16x16x16_bf16 v[32:35], v[142:143], v[86:87], v[32:35]
    v_mov_b32 v41, v60
    v_mov_b32 v43, v60
    v_mov_b32 v45, v60
    v_mov_b32 v47, v60
    v_cmp_gt_u32 vcc, 4, v3
    s_nop 2
    v_mov_b32 v40, v32
    v_mov_b32 v42, v33
    v_mov_b32 v44, v34
    v_mov_b32 v46, v35
    s_and_saveexec_b64 s[86:87], vcc
    buffer_store_dwordx4 v[40:43], v18, s[52:55], s85 offen sc1
    buffer_store_dwordx4 v[44:47], v18, s[52:55], s85 offen offset:64 sc1
    s_mov_b64 exec, s[86:87]
L_s3:
    s_nop 7
    s_cmp_lt_u32 s2, 224
    s_cbranch_scc1 L_end
    s_mov_b32 s14, 0
    s_branch L_s3poll
L_s3zpoll:
    s_nop 7
    buffer_load_dwordx2 v[144:145], v5, s[52:55], s92 offen sc1
    buffer_load_dwordx2 v[146:147], v5, s[52:55], s88 offen sc1
    buffer_load_dwordx2 v[148:149], v5, s[52:55], s89 offen sc1
    buffer_load_dwordx2 v[150:151], v5, s[52:55], s90 offen sc1
L_s3poll:
    s_nop 7
    buffer_load_dwordx2 v[72:73], v4, s[52:55], s93 offen offset:0 sc1
    buffer_load_dwordx2 v[74:75], v4, s[52:55], s93 offen offset:2048 sc1
    buffer_load_dwordx2 v[76:77], v4, s[52:55], s91 offen offset:0 sc1
    buffer_load_dwordx2 v[78:79], v4, s[52:55], s91 offen offset:2048 sc1
    s_waitcnt vmcnt(0)
    s_add_u32 s14, s14, 1
    s_cmp_ge_u32 s14, 1048576
    s_cbranch_scc1 L_s3go
    v_xor_b32 v12, v145, v60
    v_xor_b32 v13, v147, v60
    v_or_b32 v12, v12, v13
    v_xor_b32 v13, v149, v60
    v_or_b32 v12, v12, v13
    v_xor_b32 v13, v151, v60
    v_or_b32 v12, v12, v13
    v_cmp_eq_u32 vcc, 0, v12
    s_nop 0
    s_cmp_eq_u64 vcc, exec
    s_cbranch_scc0 L_s3zpoll
    v_xor_b32 v12, v73, v60
    v_xor_b32 v13, v75, v60
    v_or_b32 v12, v12, v13
    v_xor_b32 v13, v77, v60
    v_or_b32 v12, v12, v13
    v_xor_b32 v13, v79, v60
    v_or_b32 v12, v12, v13
    v_cmp_eq_u32 vcc, 0, v12
    s_nop 0
    s_cmp_eq_u64 vcc, exec
    s_cbranch_scc1 L_s3go
    s_sleep 1
    s_branch L_s3poll
L_s3go:
    s_nop 7
    v_add_f32 v32, v72, v74
    v_add_f32 v34, v76, v78
    v_add_f32 v32, v32, v34
    v_add_f32 v33, v144, v146
    v_add_f32 v33, v33, v148
    s_cmp_lt_u32 s3, 4
    s_cbranch_scc0 L_s3noz
    v_add_f32 v33, v33, v150
L_s3noz:
    s_nop 7
    v_lshlrev_b32 v7, 3, v1
    s_lshl_b32 s9, s3, 9
    s_add_u32 s9, s9, 151552
    v_add_u32 v8, s9, v7
    ds_write_b64 v8, v[32:33]
    s_waitcnt lgkmcnt(0)
    s_barrier
    s_cmp_lg_u32 s3, 0
    s_cbranch_scc1 L_end
    v_add_u32 v8, 151552, v7
    ds_read_b64 v[16:17], v8 offset:0
    ds_read_b64 v[18:19], v8 offset:512
    ds_read_b64 v[20:21], v8 offset:1024
    ds_read_b64 v[22:23], v8 offset:1536
    ds_read_b64 v[24:25], v8 offset:2048
    ds_read_b64 v[26:27], v8 offset:2560
    ds_read_b64 v[28:29], v8 offset:3072
    ds_read_b64 v[30:31], v8 offset:3584
    s_waitcnt lgkmcnt(0)
    v_add_f32 v16, v16, v18
    v_add_f32 v17, v17, v19
    v_add_f32 v16, v16, v20
    v_add_f32 v17, v17, v21
    v_add_f32 v16, v16, v22
    v_add_f32 v17, v17, v23
    v_add_f32 v16, v16, v24
    v_add_f32 v17, v17, v25
    v_add_f32 v16, v16, v26
    v_add_f32 v17, v17, v27
    v_add_f32 v16, v16, v28
    v_add_f32 v17, v17, v29
    v_add_f32 v16, v16, v30
    v_add_f32 v17, v17, v31
    v_cvt_pk_bf16_f32 v16, v16, v16
    v_lshlrev_b32 v16, 16, v16
    v_cvt_pk_bf16_f32 v17, v17, v17
    v_lshlrev_b32 v17, 16, v17
    v_lshlrev_b32 v44, 16, v152
    v_lshlrev_b32 v45, 16, v153
    v_add_f32 v17, v17, v44
    v_cvt_pk_bf16_f32 v17, v17, v17
    v_lshlrev_b32 v17, 16, v17
    v_mul_f32 v10, 0xbfb8aa3b, v17
    v_exp_f32 v10, v10
    s_nop 0
    v_add_f32 v10, 1.0, v10
    v_rcp_f32 v10, v10
    s_nop 0
    v_mul_f32 v17, v17, v10
    v_cvt_pk_bf16_f32 v17, v17, v17
    v_lshlrev_b32 v17, 16, v17
    v_mul_f32 v16, v16, v17
    v_cvt_pk_bf16_f32 v16, v16, v16
    v_lshlrev_b32 v16, 16, v16
    v_add_f32 v16, v16, v45
    v_cvt_pk_bf16_f32 v16, v16, v16
    buffer_store_short v16, v6, s[80:83], s94 offen
    s_cmp_lg_u32 s2, 255
    s_cbranch_scc1 L_end
    v_mov_b32 v17, 1
    v_mov_b32 v18, 0
    s_mov_b32 s9, 3145728
    s_mov_b64 exec, 1
    buffer_atomic_add v17, v18, s[52:55], s9 offen
    s_mov_b64 exec, -1
L_end:
    s_nop 7
L_exit:
    s_nop 7
    s_endpgm
.section .rodata,"a"
.p2align 6
.amdhsa_kernel recurrent_scan__gqa_block_cached__mixer_channel_mlp__decode_kernel
  .amdhsa_next_free_vgpr 176
  .amdhsa_next_free_sgpr 102
  .amdhsa_accum_offset 176
  .amdhsa_group_segment_fixed_size 0
  .amdhsa_kernarg_size 104
  .amdhsa_user_sgpr_count 2
  .amdhsa_user_sgpr_kernarg_segment_ptr 1
  .amdhsa_system_sgpr_workgroup_id_x 1
.end_amdhsa_kernel
```
